```python
import torch

def _softmax(x, axis=-1):
    return torch.softmax(x, dim=axis)
def _gelu(x):
    return torch.nn.functional.gelu(x, approximate="tanh")
def _silu(x):
    return torch.nn.functional.silu(x)
def _sigmoid(x):
    return torch.sigmoid(x)
def _layernorm(x, axis=-1, eps=1e-5):
    m = x.mean(dim=axis, keepdim=True)
    v = x.var(dim=axis, keepdim=True, unbiased=False)
    return (x - m) / torch.sqrt(v + eps)
def _scatter_add(tgt, idx, src, axis=0):
    return tgt.clone().index_add_(axis, idx, src)
def _segment_sum(src, seg, n):
    out = torch.zeros((n,) + src.shape[1:], dtype=src.dtype)
    return out.index_add_(0, seg, src)
def _pad(x, pw):
    flat = tuple(v for pair in reversed(pw) for v in pair)
    return torch.nn.functional.pad(x, flat)

kernel_name = 'standalone__self_sup_conv_stem_hubert__speech'

def setup_inputs():

    _w = (lambda a: (lambda t: t.to(torch.bfloat16) if t.is_floating_point() else t)(torch.as_tensor(a)))
    B, T, D, K = 2, 4000, 256, 31
    scale = (1.0 / (K * D)) ** 0.5
    return {
        "x": _w((lambda *s: torch.randn(*s, dtype=torch.bfloat16) * 0.05)(B, T, D)),
        "w": _w((lambda *s: torch.randn(*s, dtype=torch.bfloat16) * 0.05)(K, D, D) * scale),
        "b": _w((lambda *s: torch.randn(*s, dtype=torch.bfloat16) * 0.05)(D) * 0.1),
        "gamma": _w(torch.ones((D,), dtype=float)),
        "beta": _w(torch.zeros((D,), dtype=float)),
    }

def reference(x, w, b, gamma, beta):
    B, T, D = x.shape
    K = w.shape[0]
    s = 2
    L = (T - K) // s + 1
    y = torch.einsum('blc,cd->bld', x[:, 0 : s * L : s, :], w[0])
    for i in range(1, K):
        y = y + torch.einsum('blc,cd->bld', x[:, i : i + s * L : s, :], w[i])
    y = y + b[None, None, :]
    mu = y.mean(1, keepdims=True)
    var = ((y - mu) ** 2).mean(1, keepdims=True)
    yn = (y - mu) / torch.sqrt(var + 1e-5)
    yn = yn * gamma[None, None, :] + beta[None, None, :]
    return _gelu(yn)
```

```asm
; @launch kernel=standalone__self_sup_conv_stem_hubert__speech_kernel grid=(256,1,1) block=(256,1,1) lds=133120
; @launch kernel=hubert_norm_kernel grid=(250,1,1) block=(256,1,1) lds=0
.amdgcn_target "amdgcn-amd-amdhsa--gfx950"
.text
.globl standalone__self_sup_conv_stem_hubert__speech_kernel
.p2align 8
.type standalone__self_sup_conv_stem_hubert__speech_kernel,@function
standalone__self_sup_conv_stem_hubert__speech_kernel:
    s_cmp_ge_u32 s2, 256
    s_cbranch_scc1 KA_EXIT
    s_load_dwordx4 s[4:7], s[0:1], 0
    s_load_dwordx2 s[8:9], s[0:1], 16
    s_load_dwordx2 s[10:11], s[0:1], 56
    v_and_b32 v8, 63, v0
    v_lshrrev_b32 v9, 6, v0
    v_and_b32 v10, 15, v8
    v_lshrrev_b32 v11, 4, v8
    v_readfirstlane_b32 s3, v9
    v_lshlrev_b32 v1, 13, v10
    v_lshl_add_u32 v1, v11, 4, v1
    v_lshrrev_b32 v12, 2, v8
    v_and_b32 v13, 3, v8
    v_lshrrev_b32 v14, 5, v8
    v_lshlrev_b32 v14, 1, v14
    v_xor_b32 v13, v13, v14
    v_lshlrev_b32 v2, 9, v12
    v_lshl_add_u32 v2, v13, 4, v2
    v_add_u32 v3, 7168, v2
    v_add_u32 v4, 14336, v2
    v_add_u32 v5, 21504, v2
    v_lshrrev_b32 v12, 2, v10
    v_lshl_add_u32 v12, v11, 3, v12
    v_lshlrev_b32 v12, 6, v12
    v_and_b32 v13, 3, v10
    v_lshl_add_u32 v12, v13, 3, v12
    v_and_b32 v13, 1, v11
    v_lshlrev_b32 v13, 5, v13
    s_lshl_b32 s28, s3, 15
    v_add_u32 v6, v12, v13
    v_add_u32 v6, s28, v6
    v_xor_b32 v7, 32, v6
    v_lshrrev_b32 v13, 3, v8
    v_and_b32 v14, 7, v8
    v_xor_b32 v14, v14, v13
    v_lshlrev_b32 v13, 13, v13
    v_lshl_add_u32 v13, v14, 4, v13
    v_and_b32 v12, 7, v10
    v_xor_b32 v14, v11, v12
    v_lshlrev_b32 v14, 4, v14
    v_lshl_add_u32 v14, v10, 7, v14
    s_add_u32 s41, s28, 16384
    v_add_u32 v14, s41, v14
    v_mov_b32 v8, v13
    v_add_u32 v9, 0x10000, v13
    v_mov_b32 v10, v14
    v_xor_b32 v11, 64, v14
    s_and_b32 s29, s2, 3
    s_lshl_b32 s29, s29, 1
    s_bfe_u32 s42, s2, 0x10003
    s_or_b32 s29, s29, s42
    s_lshr_b32 s41, s2, 4
    s_bfe_u32 s42, s2, 0x10002
    s_lshl_b32 s42, s42, 4
    s_or_b32 s41, s41, s42
    s_lshr_b32 s38, s41, 4
    s_and_b32 s40, s41, 15
    s_lshl_b32 s39, s40, 7
    s_waitcnt lgkmcnt(0)
    s_mov_b32 s12, s4
    s_and_b32 s13, s5, 0xffff
    s_mov_b32 s14, 4096000
    s_mov_b32 s15, 0x00020000
    s_mov_b32 s16, s6
    s_and_b32 s17, s7, 0xffff
    s_mov_b32 s18, 4063232
    s_mov_b32 s19, 0x00020000
    s_mov_b32 s20, s10
    s_and_b32 s21, s11, 0xffff
    s_mov_b32 s22, 4259840
    s_mov_b32 s23, 0x00020000
    s_mov_b32 s24, s8
    s_and_b32 s25, s9, 0xffff
    s_mov_b32 s26, 512
    s_mov_b32 s27, 0x00020000
    s_mul_i32 s41, s38, 2048000
    s_lshl_b32 s42, s39, 10
    s_add_u32 s41, s41, s42
    s_lshl_b32 s42, s3, 7
    s_add_u32 s30, s41, s42
    s_add_u32 s31, s30, 4096
    s_add_u32 s32, s30, 8192
    s_add_u32 s33, s30, 12288
    s_add_u32 s34, s30, 16384
    s_add_u32 s35, s30, 20480
    s_lshl_b32 s41, s3, 15
    s_lshl_b32 s42, s29, 6
    s_add_u32 s36, s41, s42
    s_mov_b32 s46, 0x80008000
    s_mov_b32 s47, 0x80008000
    s_sub_u32 s43, 1985, s39
    s_min_u32 s43, s43, 128
    s_add_u32 s37, s36, 0
    s_add_u32 m0, s28, 0
    s_nop 0
    buffer_load_dwordx4 v2, s[16:19], s37 offen offset:0 lds
    buffer_load_dwordx4 v3, s[16:19], s37 offen offset:1024 lds
    buffer_load_dwordx4 v4, s[16:19], s37 offen offset:2048 lds
    buffer_load_dwordx4 v5, s[16:19], s37 offen offset:3072 lds
    s_add_u32 m0, s28, 16384
    s_nop 0
    buffer_load_dwordx4 v8, s[12:15], s30 offen offset:0 lds
    s_add_u32 m0, s28, 17408
    s_nop 0
    buffer_load_dwordx4 v9, s[12:15], s30 offen offset:0 lds
    s_add_u32 m0, s28, 17408
    s_nop 0
    buffer_load_dwordx4 v8, s[12:15], s30 offen offset:1024 lds
    s_add_u32 m0, s28, 18432
    s_nop 0
    buffer_load_dwordx4 v9, s[12:15], s30 offen offset:1024 lds
    s_add_u32 m0, s28, 18432
    s_nop 0
    buffer_load_dwordx4 v8, s[12:15], s30 offen offset:2048 lds
    s_add_u32 m0, s28, 19456
    s_nop 0
    buffer_load_dwordx4 v9, s[12:15], s30 offen offset:2048 lds
    s_add_u32 m0, s28, 19456
    s_nop 0
    buffer_load_dwordx4 v8, s[12:15], s30 offen offset:3072 lds
    s_add_u32 m0, s28, 20480
    s_nop 0
    buffer_load_dwordx4 v9, s[12:15], s30 offen offset:3072 lds
    s_add_u32 m0, s28, 24576
    s_nop 0
    buffer_load_dwordx4 v8, s[12:15], s31 offen offset:0 lds
    s_add_u32 m0, s28, 25600
    s_nop 0
    buffer_load_dwordx4 v9, s[12:15], s31 offen offset:0 lds
    s_add_u32 m0, s28, 25600
    s_nop 0
    buffer_load_dwordx4 v8, s[12:15], s31 offen offset:1024 lds
    s_add_u32 m0, s28, 26624
    s_nop 0
    buffer_load_dwordx4 v9, s[12:15], s31 offen offset:1024 lds
    s_add_u32 m0, s28, 26624
    s_nop 0
    buffer_load_dwordx4 v8, s[12:15], s31 offen offset:2048 lds
    s_add_u32 m0, s28, 27648
    s_nop 0
    buffer_load_dwordx4 v9, s[12:15], s31 offen offset:2048 lds
    s_add_u32 m0, s28, 27648
    s_nop 0
    buffer_load_dwordx4 v8, s[12:15], s31 offen offset:3072 lds
    s_add_u32 m0, s28, 28672
    s_nop 0
    buffer_load_dwordx4 v9, s[12:15], s31 offen offset:3072 lds
    s_add_u32 s37, s36, 262144
    s_add_u32 m0, s28, 4096
    s_nop 0
    buffer_load_dwordx4 v2, s[16:19], s37 offen offset:0 lds
    buffer_load_dwordx4 v3, s[16:19], s37 offen offset:1024 lds
    buffer_load_dwordx4 v4, s[16:19], s37 offen offset:2048 lds
    buffer_load_dwordx4 v5, s[16:19], s37 offen offset:3072 lds
    s_add_u32 s37, s36, 524288
    s_add_u32 m0, s28, 8192
    s_nop 0
    buffer_load_dwordx4 v2, s[16:19], s37 offen offset:0 lds
    buffer_load_dwordx4 v3, s[16:19], s37 offen offset:1024 lds
    buffer_load_dwordx4 v4, s[16:19], s37 offen offset:2048 lds
    buffer_load_dwordx4 v5, s[16:19], s37 offen offset:3072 lds
    s_add_u32 s37, s36, 786432
    s_add_u32 m0, s28, 12288
    s_nop 0
    buffer_load_dwordx4 v2, s[16:19], s37 offen offset:0 lds
    buffer_load_dwordx4 v3, s[16:19], s37 offen offset:1024 lds
    buffer_load_dwordx4 v4, s[16:19], s37 offen offset:2048 lds
    buffer_load_dwordx4 v5, s[16:19], s37 offen offset:3072 lds
    s_lshr_b32 s41, s2, 3
    s_lshl_b32 s41, s41, 2
    s_add_u32 s41, s41, s3
    s_lshl_b32 s41, s41, 15
    s_and_b32 s42, s2, 3
    s_lshl_b32 s42, s42, 7
    s_add_u32 s41, s41, s42
    v_and_b32 v12, 63, v0
    v_lshlrev_b32 v12, 9, v12
    v_add_u32 v12, s41, v12
    buffer_load_dword v13, v12, s[16:19], 0 offen
    v_accvgpr_write_b32 a0, 0
    v_accvgpr_write_b32 a1, 0
    v_accvgpr_write_b32 a2, 0
    v_accvgpr_write_b32 a3, 0
    v_accvgpr_write_b32 a4, 0
    v_accvgpr_write_b32 a5, 0
    v_accvgpr_write_b32 a6, 0
    v_accvgpr_write_b32 a7, 0
    v_accvgpr_write_b32 a8, 0
    v_accvgpr_write_b32 a9, 0
    v_accvgpr_write_b32 a10, 0
    v_accvgpr_write_b32 a11, 0
    v_accvgpr_write_b32 a12, 0
    v_accvgpr_write_b32 a13, 0
    v_accvgpr_write_b32 a14, 0
    v_accvgpr_write_b32 a15, 0
    v_accvgpr_write_b32 a16, 0
    v_accvgpr_write_b32 a17, 0
    v_accvgpr_write_b32 a18, 0
    v_accvgpr_write_b32 a19, 0
    v_accvgpr_write_b32 a20, 0
    v_accvgpr_write_b32 a21, 0
    v_accvgpr_write_b32 a22, 0
    v_accvgpr_write_b32 a23, 0
    v_accvgpr_write_b32 a24, 0
    v_accvgpr_write_b32 a25, 0
    v_accvgpr_write_b32 a26, 0
    v_accvgpr_write_b32 a27, 0
    v_accvgpr_write_b32 a28, 0
    v_accvgpr_write_b32 a29, 0
    v_accvgpr_write_b32 a30, 0
    v_accvgpr_write_b32 a31, 0
    v_accvgpr_write_b32 a32, 0
    v_accvgpr_write_b32 a33, 0
    v_accvgpr_write_b32 a34, 0
    v_accvgpr_write_b32 a35, 0
    v_accvgpr_write_b32 a36, 0
    v_accvgpr_write_b32 a37, 0
    v_accvgpr_write_b32 a38, 0
    v_accvgpr_write_b32 a39, 0
    v_accvgpr_write_b32 a40, 0
    v_accvgpr_write_b32 a41, 0
    v_accvgpr_write_b32 a42, 0
    v_accvgpr_write_b32 a43, 0
    v_accvgpr_write_b32 a44, 0
    v_accvgpr_write_b32 a45, 0
    v_accvgpr_write_b32 a46, 0
    v_accvgpr_write_b32 a47, 0
    v_accvgpr_write_b32 a48, 0
    v_accvgpr_write_b32 a49, 0
    v_accvgpr_write_b32 a50, 0
    v_accvgpr_write_b32 a51, 0
    v_accvgpr_write_b32 a52, 0
    v_accvgpr_write_b32 a53, 0
    v_accvgpr_write_b32 a54, 0
    v_accvgpr_write_b32 a55, 0
    v_accvgpr_write_b32 a56, 0
    v_accvgpr_write_b32 a57, 0
    v_accvgpr_write_b32 a58, 0
    v_accvgpr_write_b32 a59, 0
    v_accvgpr_write_b32 a60, 0
    v_accvgpr_write_b32 a61, 0
    v_accvgpr_write_b32 a62, 0
    v_accvgpr_write_b32 a63, 0
    s_waitcnt vmcnt(29)
    ds_read_b64_tr_b16 v[144:145], v6 offset:0
    ds_read_b64_tr_b16 v[146:147], v6 offset:256
    ds_read_b64_tr_b16 v[148:149], v7 offset:0
    ds_read_b64_tr_b16 v[150:151], v7 offset:256
    ds_read_b64_tr_b16 v[152:153], v6 offset:2048
    ds_read_b64_tr_b16 v[154:155], v6 offset:2304
    ds_read_b64_tr_b16 v[156:157], v7 offset:2048
    ds_read_b64_tr_b16 v[158:159], v7 offset:2304
    s_waitcnt vmcnt(27)
    ds_read_b128 v[16:19], v10 offset:0
    ds_read_b128 v[20:23], v11 offset:0
    s_waitcnt vmcnt(25)
    ds_read_b128 v[24:27], v10 offset:2048
    ds_read_b128 v[28:31], v11 offset:2048
    s_waitcnt vmcnt(23)
    ds_read_b128 v[32:35], v10 offset:4096
    ds_read_b128 v[36:39], v11 offset:4096
    s_waitcnt vmcnt(21)
    ds_read_b128 v[40:43], v10 offset:6144
    ds_read_b128 v[44:47], v11 offset:6144
    s_waitcnt vmcnt(19)
    ds_read_b128 v[48:51], v10 offset:8192
    ds_read_b128 v[52:55], v11 offset:8192
    s_waitcnt vmcnt(17)
    ds_read_b128 v[56:59], v10 offset:10240
    ds_read_b128 v[60:63], v11 offset:10240
    s_waitcnt vmcnt(15)
    ds_read_b128 v[64:67], v10 offset:12288
    ds_read_b128 v[68:71], v11 offset:12288
    s_waitcnt vmcnt(13)
    ds_read_b128 v[72:75], v10 offset:14336
    ds_read_b128 v[76:79], v11 offset:14336
    s_waitcnt lgkmcnt(0)
    v_mfma_f32_16x16x32_bf16 a[0:3], v[16:19], v[144:147], a[0:3]
    v_mfma_f32_16x16x32_bf16 a[4:7], v[16:19], v[148:151], a[4:7]
    v_mfma_f32_16x16x32_bf16 a[0:3], v[20:23], v[152:155], a[0:3]
    v_mfma_f32_16x16x32_bf16 a[4:7], v[20:23], v[156:159], a[4:7]
    v_mov_b32_dpp v16, v16 row_shl:1 row_mask:0xf bank_mask:0xf
    v_mfma_f32_16x16x32_bf16 a[8:11], v[24:27], v[144:147], a[8:11]
    v_mov_b32_dpp v17, v17 row_shl:1 row_mask:0xf bank_mask:0xf
    v_mfma_f32_16x16x32_bf16 a[12:15], v[24:27], v[148:151], a[12:15]
    v_mov_b32_dpp v18, v18 row_shl:1 row_mask:0xf bank_mask:0xf
    v_mfma_f32_16x16x32_bf16 a[8:11], v[28:31], v[152:155], a[8:11]
    v_mov_b32_dpp v19, v19 row_shl:1 row_mask:0xf bank_mask:0xf
    v_mfma_f32_16x16x32_bf16 a[12:15], v[28:31], v[156:159], a[12:15]
    v_mov_b32_dpp v20, v20 row_shl:1 row_mask:0xf bank_mask:0xf
    v_mfma_f32_16x16x32_bf16 a[16:19], v[32:35], v[144:147], a[16:19]
    v_mov_b32_dpp v21, v21 row_shl:1 row_mask:0xf bank_mask:0xf
    v_mfma_f32_16x16x32_bf16 a[20:23], v[32:35], v[148:151], a[20:23]
    v_mov_b32_dpp v22, v22 row_shl:1 row_mask:0xf bank_mask:0xf
    v_mfma_f32_16x16x32_bf16 a[16:19], v[36:39], v[152:155], a[16:19]
    v_mov_b32_dpp v23, v23 row_shl:1 row_mask:0xf bank_mask:0xf
    v_mfma_f32_16x16x32_bf16 a[20:23], v[36:39], v[156:159], a[20:23]
    s_mov_b64 exec, s[46:47]
    buffer_load_dwordx4 v[16:19], v1, s[12:15], s32 offen offset:0
    buffer_load_dwordx4 v[20:23], v1, s[12:15], s32 offen offset:64
    s_mov_b64 exec, -1
    v_mfma_f32_16x16x32_bf16 a[24:27], v[40:43], v[144:147], a[24:27]
    v_mfma_f32_16x16x32_bf16 a[28:31], v[40:43], v[148:151], a[28:31]
    s_add_u32 s37, s36, 1048576
    s_add_u32 m0, s28, 0
    v_mfma_f32_16x16x32_bf16 a[24:27], v[44:47], v[152:155], a[24:27]
    buffer_load_dwordx4 v2, s[16:19], s37 offen offset:0 lds
    v_mfma_f32_16x16x32_bf16 a[28:31], v[44:47], v[156:159], a[28:31]
    buffer_load_dwordx4 v3, s[16:19], s37 offen offset:1024 lds
    v_mfma_f32_16x16x32_bf16 a[32:35], v[48:51], v[144:147], a[32:35]
    buffer_load_dwordx4 v4, s[16:19], s37 offen offset:2048 lds
    v_mfma_f32_16x16x32_bf16 a[36:39], v[48:51], v[148:151], a[36:39]
    buffer_load_dwordx4 v5, s[16:19], s37 offen offset:3072 lds
    v_mfma_f32_16x16x32_bf16 a[32:35], v[52:55], v[152:155], a[32:35]
    s_waitcnt vmcnt(15)
    ds_read_b64_tr_b16 v[160:161], v6 offset:4096
    v_mfma_f32_16x16x32_bf16 a[36:39], v[52:55], v[156:159], a[36:39]
    ds_read_b64_tr_b16 v[162:163], v6 offset:4352
    v_mfma_f32_16x16x32_bf16 a[40:43], v[56:59], v[144:147], a[40:43]
    ds_read_b64_tr_b16 v[164:165], v7 offset:4096
    v_mfma_f32_16x16x32_bf16 a[44:47], v[56:59], v[148:151], a[44:47]
    ds_read_b64_tr_b16 v[166:167], v7 offset:4352
    v_mfma_f32_16x16x32_bf16 a[40:43], v[60:63], v[152:155], a[40:43]
    ds_read_b64_tr_b16 v[168:169], v6 offset:6144
    v_mfma_f32_16x16x32_bf16 a[44:47], v[60:63], v[156:159], a[44:47]
    ds_read_b64_tr_b16 v[170:171], v6 offset:6400
    v_mfma_f32_16x16x32_bf16 a[48:51], v[64:67], v[144:147], a[48:51]
    ds_read_b64_tr_b16 v[172:173], v7 offset:6144
    v_mfma_f32_16x16x32_bf16 a[52:55], v[64:67], v[148:151], a[52:55]
    ds_read_b64_tr_b16 v[174:175], v7 offset:6400
    v_mfma_f32_16x16x32_bf16 a[48:51], v[68:71], v[152:155], a[48:51]
    v_mfma_f32_16x16x32_bf16 a[52:55], v[68:71], v[156:159], a[52:55]
    v_mfma_f32_16x16x32_bf16 a[56:59], v[72:75], v[144:147], a[56:59]
    v_mfma_f32_16x16x32_bf16 a[60:63], v[72:75], v[148:151], a[60:63]
    v_mfma_f32_16x16x32_bf16 a[56:59], v[76:79], v[152:155], a[56:59]
    v_mfma_f32_16x16x32_bf16 a[60:63], v[76:79], v[156:159], a[60:63]
    s_waitcnt lgkmcnt(0)
    v_mfma_f32_16x16x32_bf16 a[0:3], v[24:27], v[160:163], a[0:3]
    v_mfma_f32_16x16x32_bf16 a[4:7], v[24:27], v[164:167], a[4:7]
    v_mfma_f32_16x16x32_bf16 a[0:3], v[28:31], v[168:171], a[0:3]
    v_mfma_f32_16x16x32_bf16 a[4:7], v[28:31], v[172:175], a[4:7]
    v_mov_b32_dpp v24, v24 row_shl:1 row_mask:0xf bank_mask:0xf
    v_mfma_f32_16x16x32_bf16 a[8:11], v[32:35], v[160:163], a[8:11]
    v_mov_b32_dpp v25, v25 row_shl:1 row_mask:0xf bank_mask:0xf
    v_mfma_f32_16x16x32_bf16 a[12:15], v[32:35], v[164:167], a[12:15]
    v_mov_b32_dpp v26, v26 row_shl:1 row_mask:0xf bank_mask:0xf
    v_mfma_f32_16x16x32_bf16 a[8:11], v[36:39], v[168:171], a[8:11]
    v_mov_b32_dpp v27, v27 row_shl:1 row_mask:0xf bank_mask:0xf
    v_mfma_f32_16x16x32_bf16 a[12:15], v[36:39], v[172:175], a[12:15]
    v_mov_b32_dpp v28, v28 row_shl:1 row_mask:0xf bank_mask:0xf
    v_mfma_f32_16x16x32_bf16 a[16:19], v[40:43], v[160:163], a[16:19]
    v_mov_b32_dpp v29, v29 row_shl:1 row_mask:0xf bank_mask:0xf
    v_mfma_f32_16x16x32_bf16 a[20:23], v[40:43], v[164:167], a[20:23]
    v_mov_b32_dpp v30, v30 row_shl:1 row_mask:0xf bank_mask:0xf
    v_mfma_f32_16x16x32_bf16 a[16:19], v[44:47], v[168:171], a[16:19]
    v_mov_b32_dpp v31, v31 row_shl:1 row_mask:0xf bank_mask:0xf
    v_mfma_f32_16x16x32_bf16 a[20:23], v[44:47], v[172:175], a[20:23]
    s_mov_b64 exec, s[46:47]
    buffer_load_dwordx4 v[24:27], v1, s[12:15], s32 offen offset:1024
    buffer_load_dwordx4 v[28:31], v1, s[12:15], s32 offen offset:1088
    s_mov_b64 exec, -1
    v_mfma_f32_16x16x32_bf16 a[24:27], v[48:51], v[160:163], a[24:27]
    v_mfma_f32_16x16x32_bf16 a[28:31], v[48:51], v[164:167], a[28:31]
    s_add_u32 s37, s36, 1310720
    s_add_u32 m0, s28, 4096
    v_mfma_f32_16x16x32_bf16 a[24:27], v[52:55], v[168:171], a[24:27]
    buffer_load_dwordx4 v2, s[16:19], s37 offen offset:0 lds
    v_mfma_f32_16x16x32_bf16 a[28:31], v[52:55], v[172:175], a[28:31]
    buffer_load_dwordx4 v3, s[16:19], s37 offen offset:1024 lds
    v_mfma_f32_16x16x32_bf16 a[32:35], v[56:59], v[160:163], a[32:35]
    buffer_load_dwordx4 v4, s[16:19], s37 offen offset:2048 lds
    v_mfma_f32_16x16x32_bf16 a[36:39], v[56:59], v[164:167], a[36:39]
    buffer_load_dwordx4 v5, s[16:19], s37 offen offset:3072 lds
    v_mfma_f32_16x16x32_bf16 a[32:35], v[60:63], v[168:171], a[32:35]
    s_waitcnt vmcnt(17)
    ds_read_b64_tr_b16 v[144:145], v6 offset:8192
    v_mfma_f32_16x16x32_bf16 a[36:39], v[60:63], v[172:175], a[36:39]
    ds_read_b64_tr_b16 v[146:147], v6 offset:8448
    v_mfma_f32_16x16x32_bf16 a[40:43], v[64:67], v[160:163], a[40:43]
    ds_read_b64_tr_b16 v[148:149], v7 offset:8192
    v_mfma_f32_16x16x32_bf16 a[44:47], v[64:67], v[164:167], a[44:47]
    ds_read_b64_tr_b16 v[150:151], v7 offset:8448
    v_mfma_f32_16x16x32_bf16 a[40:43], v[68:71], v[168:171], a[40:43]
    ds_read_b64_tr_b16 v[152:153], v6 offset:10240
    v_mfma_f32_16x16x32_bf16 a[44:47], v[68:71], v[172:175], a[44:47]
    ds_read_b64_tr_b16 v[154:155], v6 offset:10496
    v_mfma_f32_16x16x32_bf16 a[48:51], v[72:75], v[160:163], a[48:51]
    ds_read_b64_tr_b16 v[156:157], v7 offset:10240
    v_mfma_f32_16x16x32_bf16 a[52:55], v[72:75], v[164:167], a[52:55]
    ds_read_b64_tr_b16 v[158:159], v7 offset:10496
    v_mfma_f32_16x16x32_bf16 a[48:51], v[76:79], v[168:171], a[48:51]
    v_mfma_f32_16x16x32_bf16 a[52:55], v[76:79], v[172:175], a[52:55]
    s_waitcnt vmcnt(10)
    v_mfma_f32_16x16x32_bf16 a[56:59], v[16:19], v[160:163], a[56:59]
    v_mfma_f32_16x16x32_bf16 a[60:63], v[16:19], v[164:167], a[60:63]
    v_mfma_f32_16x16x32_bf16 a[56:59], v[20:23], v[168:171], a[56:59]
    v_mfma_f32_16x16x32_bf16 a[60:63], v[20:23], v[172:175], a[60:63]
    s_waitcnt lgkmcnt(0)
    v_mfma_f32_16x16x32_bf16 a[0:3], v[32:35], v[144:147], a[0:3]
    v_mfma_f32_16x16x32_bf16 a[4:7], v[32:35], v[148:151], a[4:7]
    v_mfma_f32_16x16x32_bf16 a[0:3], v[36:39], v[152:155], a[0:3]
    v_mfma_f32_16x16x32_bf16 a[4:7], v[36:39], v[156:159], a[4:7]
    v_mov_b32_dpp v32, v32 row_shl:1 row_mask:0xf bank_mask:0xf
    v_mfma_f32_16x16x32_bf16 a[8:11], v[40:43], v[144:147], a[8:11]
    v_mov_b32_dpp v33, v33 row_shl:1 row_mask:0xf bank_mask:0xf
    v_mfma_f32_16x16x32_bf16 a[12:15], v[40:43], v[148:151], a[12:15]
    v_mov_b32_dpp v34, v34 row_shl:1 row_mask:0xf bank_mask:0xf
    v_mfma_f32_16x16x32_bf16 a[8:11], v[44:47], v[152:155], a[8:11]
    v_mov_b32_dpp v35, v35 row_shl:1 row_mask:0xf bank_mask:0xf
    v_mfma_f32_16x16x32_bf16 a[12:15], v[44:47], v[156:159], a[12:15]
    v_mov_b32_dpp v36, v36 row_shl:1 row_mask:0xf bank_mask:0xf
    v_mfma_f32_16x16x32_bf16 a[16:19], v[48:51], v[144:147], a[16:19]
    v_mov_b32_dpp v37, v37 row_shl:1 row_mask:0xf bank_mask:0xf
    v_mfma_f32_16x16x32_bf16 a[20:23], v[48:51], v[148:151], a[20:23]
    v_mov_b32_dpp v38, v38 row_shl:1 row_mask:0xf bank_mask:0xf
    v_mfma_f32_16x16x32_bf16 a[16:19], v[52:55], v[152:155], a[16:19]
    v_mov_b32_dpp v39, v39 row_shl:1 row_mask:0xf bank_mask:0xf
    v_mfma_f32_16x16x32_bf16 a[20:23], v[52:55], v[156:159], a[20:23]
    s_mov_b64 exec, s[46:47]
    buffer_load_dwordx4 v[32:35], v1, s[12:15], s32 offen offset:2048
    buffer_load_dwordx4 v[36:39], v1, s[12:15], s32 offen offset:2112
    s_mov_b64 exec, -1
    v_mfma_f32_16x16x32_bf16 a[24:27], v[56:59], v[144:147], a[24:27]
    v_mfma_f32_16x16x32_bf16 a[28:31], v[56:59], v[148:151], a[28:31]
    s_add_u32 s37, s36, 1572864
    s_add_u32 m0, s28, 8192
    v_mfma_f32_16x16x32_bf16 a[24:27], v[60:63], v[152:155], a[24:27]
    buffer_load_dwordx4 v2, s[16:19], s37 offen offset:0 lds
    v_mfma_f32_16x16x32_bf16 a[28:31], v[60:63], v[156:159], a[28:31]
    buffer_load_dwordx4 v3, s[16:19], s37 offen offset:1024 lds
    v_mfma_f32_16x16x32_bf16 a[32:35], v[64:67], v[144:147], a[32:35]
    buffer_load_dwordx4 v4, s[16:19], s37 offen offset:2048 lds
    v_mfma_f32_16x16x32_bf16 a[36:39], v[64:67], v[148:151], a[36:39]
    buffer_load_dwordx4 v5, s[16:19], s37 offen offset:3072 lds
    v_mfma_f32_16x16x32_bf16 a[32:35], v[68:71], v[152:155], a[32:35]
    ds_read_b64_tr_b16 v[160:161], v6 offset:12288
    v_mfma_f32_16x16x32_bf16 a[36:39], v[68:71], v[156:159], a[36:39]
    ds_read_b64_tr_b16 v[162:163], v6 offset:12544
    v_mfma_f32_16x16x32_bf16 a[40:43], v[72:75], v[144:147], a[40:43]
    ds_read_b64_tr_b16 v[164:165], v7 offset:12288
    v_mfma_f32_16x16x32_bf16 a[44:47], v[72:75], v[148:151], a[44:47]
    ds_read_b64_tr_b16 v[166:167], v7 offset:12544
    v_mfma_f32_16x16x32_bf16 a[40:43], v[76:79], v[152:155], a[40:43]
    ds_read_b64_tr_b16 v[168:169], v6 offset:14336
    v_mfma_f32_16x16x32_bf16 a[44:47], v[76:79], v[156:159], a[44:47]
    ds_read_b64_tr_b16 v[170:171], v6 offset:14592
    v_mfma_f32_16x16x32_bf16 a[48:51], v[16:19], v[144:147], a[48:51]
    ds_read_b64_tr_b16 v[172:173], v7 offset:14336
    v_mfma_f32_16x16x32_bf16 a[52:55], v[16:19], v[148:151], a[52:55]
    ds_read_b64_tr_b16 v[174:175], v7 offset:14592
    v_mfma_f32_16x16x32_bf16 a[48:51], v[20:23], v[152:155], a[48:51]
    v_mfma_f32_16x16x32_bf16 a[52:55], v[20:23], v[156:159], a[52:55]
    s_waitcnt vmcnt(10)
    v_mfma_f32_16x16x32_bf16 a[56:59], v[24:27], v[144:147], a[56:59]
    v_mfma_f32_16x16x32_bf16 a[60:63], v[24:27], v[148:151], a[60:63]
    v_mfma_f32_16x16x32_bf16 a[56:59], v[28:31], v[152:155], a[56:59]
    v_mfma_f32_16x16x32_bf16 a[60:63], v[28:31], v[156:159], a[60:63]
    s_waitcnt lgkmcnt(0)
    v_mfma_f32_16x16x32_bf16 a[0:3], v[40:43], v[160:163], a[0:3]
    v_mfma_f32_16x16x32_bf16 a[4:7], v[40:43], v[164:167], a[4:7]
    v_mfma_f32_16x16x32_bf16 a[0:3], v[44:47], v[168:171], a[0:3]
    v_mfma_f32_16x16x32_bf16 a[4:7], v[44:47], v[172:175], a[4:7]
    v_mov_b32_dpp v40, v40 row_shl:1 row_mask:0xf bank_mask:0xf
    v_mfma_f32_16x16x32_bf16 a[8:11], v[48:51], v[160:163], a[8:11]
    v_mov_b32_dpp v41, v41 row_shl:1 row_mask:0xf bank_mask:0xf
    v_mfma_f32_16x16x32_bf16 a[12:15], v[48:51], v[164:167], a[12:15]
    v_mov_b32_dpp v42, v42 row_shl:1 row_mask:0xf bank_mask:0xf
    v_mfma_f32_16x16x32_bf16 a[8:11], v[52:55], v[168:171], a[8:11]
    v_mov_b32_dpp v43, v43 row_shl:1 row_mask:0xf bank_mask:0xf
    v_mfma_f32_16x16x32_bf16 a[12:15], v[52:55], v[172:175], a[12:15]
    v_mov_b32_dpp v44, v44 row_shl:1 row_mask:0xf bank_mask:0xf
    v_mfma_f32_16x16x32_bf16 a[16:19], v[56:59], v[160:163], a[16:19]
    v_mov_b32_dpp v45, v45 row_shl:1 row_mask:0xf bank_mask:0xf
    v_mfma_f32_16x16x32_bf16 a[20:23], v[56:59], v[164:167], a[20:23]
    v_mov_b32_dpp v46, v46 row_shl:1 row_mask:0xf bank_mask:0xf
    v_mfma_f32_16x16x32_bf16 a[16:19], v[60:63], v[168:171], a[16:19]
    v_mov_b32_dpp v47, v47 row_shl:1 row_mask:0xf bank_mask:0xf
    v_mfma_f32_16x16x32_bf16 a[20:23], v[60:63], v[172:175], a[20:23]
    s_mov_b64 exec, s[46:47]
    buffer_load_dwordx4 v[40:43], v1, s[12:15], s32 offen offset:3072
    buffer_load_dwordx4 v[44:47], v1, s[12:15], s32 offen offset:3136
    s_mov_b64 exec, -1
    v_mfma_f32_16x16x32_bf16 a[24:27], v[64:67], v[160:163], a[24:27]
    v_mfma_f32_16x16x32_bf16 a[28:31], v[64:67], v[164:167], a[28:31]
    s_add_u32 s37, s36, 1835008
    s_add_u32 m0, s28, 12288
    v_mfma_f32_16x16x32_bf16 a[24:27], v[68:71], v[168:171], a[24:27]
    buffer_load_dwordx4 v2, s[16:19], s37 offen offset:0 lds
    v_mfma_f32_16x16x32_bf16 a[28:31], v[68:71], v[172:175], a[28:31]
    buffer_load_dwordx4 v3, s[16:19], s37 offen offset:1024 lds
    v_mfma_f32_16x16x32_bf16 a[32:35], v[72:75], v[160:163], a[32:35]
    buffer_load_dwordx4 v4, s[16:19], s37 offen offset:2048 lds
    v_mfma_f32_16x16x32_bf16 a[36:39], v[72:75], v[164:167], a[36:39]
    buffer_load_dwordx4 v5, s[16:19], s37 offen offset:3072 lds
    v_mfma_f32_16x16x32_bf16 a[32:35], v[76:79], v[168:171], a[32:35]
    ds_read_b64_tr_b16 v[144:145], v6 offset:0
    v_mfma_f32_16x16x32_bf16 a[36:39], v[76:79], v[172:175], a[36:39]
    ds_read_b64_tr_b16 v[146:147], v6 offset:256
    v_mfma_f32_16x16x32_bf16 a[40:43], v[16:19], v[160:163], a[40:43]
    ds_read_b64_tr_b16 v[148:149], v7 offset:0
    v_mfma_f32_16x16x32_bf16 a[44:47], v[16:19], v[164:167], a[44:47]
    ds_read_b64_tr_b16 v[150:151], v7 offset:256
    v_mfma_f32_16x16x32_bf16 a[40:43], v[20:23], v[168:171], a[40:43]
    ds_read_b64_tr_b16 v[152:153], v6 offset:2048
    v_mfma_f32_16x16x32_bf16 a[44:47], v[20:23], v[172:175], a[44:47]
    ds_read_b64_tr_b16 v[154:155], v6 offset:2304
    v_mfma_f32_16x16x32_bf16 a[48:51], v[24:27], v[160:163], a[48:51]
    ds_read_b64_tr_b16 v[156:157], v7 offset:2048
    v_mfma_f32_16x16x32_bf16 a[52:55], v[24:27], v[164:167], a[52:55]
    ds_read_b64_tr_b16 v[158:159], v7 offset:2304
    v_mfma_f32_16x16x32_bf16 a[48:51], v[28:31], v[168:171], a[48:51]
    v_mfma_f32_16x16x32_bf16 a[52:55], v[28:31], v[172:175], a[52:55]
    s_waitcnt vmcnt(10)
    v_mfma_f32_16x16x32_bf16 a[56:59], v[32:35], v[160:163], a[56:59]
    v_mfma_f32_16x16x32_bf16 a[60:63], v[32:35], v[164:167], a[60:63]
    v_mfma_f32_16x16x32_bf16 a[56:59], v[36:39], v[168:171], a[56:59]
    v_mfma_f32_16x16x32_bf16 a[60:63], v[36:39], v[172:175], a[60:63]
    s_waitcnt lgkmcnt(0)
    v_mfma_f32_16x16x32_bf16 a[0:3], v[48:51], v[144:147], a[0:3]
    v_mfma_f32_16x16x32_bf16 a[4:7], v[48:51], v[148:151], a[4:7]
    v_mfma_f32_16x16x32_bf16 a[0:3], v[52:55], v[152:155], a[0:3]
    v_mfma_f32_16x16x32_bf16 a[4:7], v[52:55], v[156:159], a[4:7]
    v_mov_b32_dpp v48, v48 row_shl:1 row_mask:0xf bank_mask:0xf
    v_mfma_f32_16x16x32_bf16 a[8:11], v[56:59], v[144:147], a[8:11]
    v_mov_b32_dpp v49, v49 row_shl:1 row_mask:0xf bank_mask:0xf
    v_mfma_f32_16x16x32_bf16 a[12:15], v[56:59], v[148:151], a[12:15]
    v_mov_b32_dpp v50, v50 row_shl:1 row_mask:0xf bank_mask:0xf
    v_mfma_f32_16x16x32_bf16 a[8:11], v[60:63], v[152:155], a[8:11]
    v_mov_b32_dpp v51, v51 row_shl:1 row_mask:0xf bank_mask:0xf
    v_mfma_f32_16x16x32_bf16 a[12:15], v[60:63], v[156:159], a[12:15]
    v_mov_b32_dpp v52, v52 row_shl:1 row_mask:0xf bank_mask:0xf
    v_mfma_f32_16x16x32_bf16 a[16:19], v[64:67], v[144:147], a[16:19]
    v_mov_b32_dpp v53, v53 row_shl:1 row_mask:0xf bank_mask:0xf
    v_mfma_f32_16x16x32_bf16 a[20:23], v[64:67], v[148:151], a[20:23]
    v_mov_b32_dpp v54, v54 row_shl:1 row_mask:0xf bank_mask:0xf
    v_mfma_f32_16x16x32_bf16 a[16:19], v[68:71], v[152:155], a[16:19]
    v_mov_b32_dpp v55, v55 row_shl:1 row_mask:0xf bank_mask:0xf
    v_mfma_f32_16x16x32_bf16 a[20:23], v[68:71], v[156:159], a[20:23]
    s_mov_b64 exec, s[46:47]
    buffer_load_dwordx4 v[48:51], v1, s[12:15], s33 offen offset:0
    buffer_load_dwordx4 v[52:55], v1, s[12:15], s33 offen offset:64
    s_mov_b64 exec, -1
    v_mfma_f32_16x16x32_bf16 a[24:27], v[72:75], v[144:147], a[24:27]
    v_mfma_f32_16x16x32_bf16 a[28:31], v[72:75], v[148:151], a[28:31]
    s_add_u32 s37, s36, 2097152
    s_add_u32 m0, s28, 0
    v_mfma_f32_16x16x32_bf16 a[24:27], v[76:79], v[152:155], a[24:27]
    buffer_load_dwordx4 v2, s[16:19], s37 offen offset:0 lds
    v_mfma_f32_16x16x32_bf16 a[28:31], v[76:79], v[156:159], a[28:31]
    buffer_load_dwordx4 v3, s[16:19], s37 offen offset:1024 lds
    v_mfma_f32_16x16x32_bf16 a[32:35], v[16:19], v[144:147], a[32:35]
    buffer_load_dwordx4 v4, s[16:19], s37 offen offset:2048 lds
    v_mfma_f32_16x16x32_bf16 a[36:39], v[16:19], v[148:151], a[36:39]
    buffer_load_dwordx4 v5, s[16:19], s37 offen offset:3072 lds
    v_mfma_f32_16x16x32_bf16 a[32:35], v[20:23], v[152:155], a[32:35]
    ds_read_b64_tr_b16 v[160:161], v6 offset:4096
    v_mfma_f32_16x16x32_bf16 a[36:39], v[20:23], v[156:159], a[36:39]
    ds_read_b64_tr_b16 v[162:163], v6 offset:4352
    v_mfma_f32_16x16x32_bf16 a[40:43], v[24:27], v[144:147], a[40:43]
    ds_read_b64_tr_b16 v[164:165], v7 offset:4096
    v_mfma_f32_16x16x32_bf16 a[44:47], v[24:27], v[148:151], a[44:47]
    ds_read_b64_tr_b16 v[166:167], v7 offset:4352
    v_mfma_f32_16x16x32_bf16 a[40:43], v[28:31], v[152:155], a[40:43]
    ds_read_b64_tr_b16 v[168:169], v6 offset:6144
    v_mfma_f32_16x16x32_bf16 a[44:47], v[28:31], v[156:159], a[44:47]
    ds_read_b64_tr_b16 v[170:171], v6 offset:6400
    v_mfma_f32_16x16x32_bf16 a[48:51], v[32:35], v[144:147], a[48:51]
    ds_read_b64_tr_b16 v[172:173], v7 offset:6144
    v_mfma_f32_16x16x32_bf16 a[52:55], v[32:35], v[148:151], a[52:55]
    ds_read_b64_tr_b16 v[174:175], v7 offset:6400
    v_mfma_f32_16x16x32_bf16 a[48:51], v[36:39], v[152:155], a[48:51]
    s_add_u32 m0, s28, 15872
    v_mfma_f32_16x16x32_bf16 a[52:55], v[36:39], v[156:159], a[52:55]
    s_waitcnt vmcnt(10)
    buffer_load_dwordx4 v8, s[12:15], s30 offen offset:512 lds
    v_mfma_f32_16x16x32_bf16 a[56:59], v[40:43], v[144:147], a[56:59]
    s_add_u32 m0, s28, 16896
    v_mfma_f32_16x16x32_bf16 a[60:63], v[40:43], v[148:151], a[60:63]
    buffer_load_dwordx4 v9, s[12:15], s30 offen offset:512 lds
    v_mfma_f32_16x16x32_bf16 a[56:59], v[44:47], v[152:155], a[56:59]
    v_mfma_f32_16x16x32_bf16 a[60:63], v[44:47], v[156:159], a[60:63]
    s_waitcnt lgkmcnt(0)
    v_mfma_f32_16x16x32_bf16 a[0:3], v[56:59], v[160:163], a[0:3]
    v_mfma_f32_16x16x32_bf16 a[4:7], v[56:59], v[164:167], a[4:7]
    v_mfma_f32_16x16x32_bf16 a[0:3], v[60:63], v[168:171], a[0:3]
    v_mfma_f32_16x16x32_bf16 a[4:7], v[60:63], v[172:175], a[4:7]
    v_mov_b32_dpp v56, v56 row_shl:1 row_mask:0xf bank_mask:0xf
    v_mfma_f32_16x16x32_bf16 a[8:11], v[64:67], v[160:163], a[8:11]
    v_mov_b32_dpp v57, v57 row_shl:1 row_mask:0xf bank_mask:0xf
    v_mfma_f32_16x16x32_bf16 a[12:15], v[64:67], v[164:167], a[12:15]
    v_mov_b32_dpp v58, v58 row_shl:1 row_mask:0xf bank_mask:0xf
    v_mfma_f32_16x16x32_bf16 a[8:11], v[68:71], v[168:171], a[8:11]
    v_mov_b32_dpp v59, v59 row_shl:1 row_mask:0xf bank_mask:0xf
    v_mfma_f32_16x16x32_bf16 a[12:15], v[68:71], v[172:175], a[12:15]
    v_mov_b32_dpp v60, v60 row_shl:1 row_mask:0xf bank_mask:0xf
    v_mfma_f32_16x16x32_bf16 a[16:19], v[72:75], v[160:163], a[16:19]
    v_mov_b32_dpp v61, v61 row_shl:1 row_mask:0xf bank_mask:0xf
    v_mfma_f32_16x16x32_bf16 a[20:23], v[72:75], v[164:167], a[20:23]
    v_mov_b32_dpp v62, v62 row_shl:1 row_mask:0xf bank_mask:0xf
    v_mfma_f32_16x16x32_bf16 a[16:19], v[76:79], v[168:171], a[16:19]
    v_mov_b32_dpp v63, v63 row_shl:1 row_mask:0xf bank_mask:0xf
    v_mfma_f32_16x16x32_bf16 a[20:23], v[76:79], v[172:175], a[20:23]
    s_mov_b64 exec, s[46:47]
    buffer_load_dwordx4 v[56:59], v1, s[12:15], s33 offen offset:1024
    buffer_load_dwordx4 v[60:63], v1, s[12:15], s33 offen offset:1088
    s_mov_b64 exec, -1
    v_mfma_f32_16x16x32_bf16 a[24:27], v[16:19], v[160:163], a[24:27]
    v_mfma_f32_16x16x32_bf16 a[28:31], v[16:19], v[164:167], a[28:31]
    s_add_u32 s37, s36, 2359296
    s_add_u32 m0, s28, 4096
    v_mfma_f32_16x16x32_bf16 a[24:27], v[20:23], v[168:171], a[24:27]
    buffer_load_dwordx4 v2, s[16:19], s37 offen offset:0 lds
    v_mfma_f32_16x16x32_bf16 a[28:31], v[20:23], v[172:175], a[28:31]
    buffer_load_dwordx4 v3, s[16:19], s37 offen offset:1024 lds
    v_mfma_f32_16x16x32_bf16 a[32:35], v[24:27], v[160:163], a[32:35]
    buffer_load_dwordx4 v4, s[16:19], s37 offen offset:2048 lds
    v_mfma_f32_16x16x32_bf16 a[36:39], v[24:27], v[164:167], a[36:39]
    buffer_load_dwordx4 v5, s[16:19], s37 offen offset:3072 lds
    v_mfma_f32_16x16x32_bf16 a[32:35], v[28:31], v[168:171], a[32:35]
    ds_read_b64_tr_b16 v[144:145], v6 offset:8192
    v_mfma_f32_16x16x32_bf16 a[36:39], v[28:31], v[172:175], a[36:39]
    ds_read_b64_tr_b16 v[146:147], v6 offset:8448
    v_mfma_f32_16x16x32_bf16 a[40:43], v[32:35], v[160:163], a[40:43]
    ds_read_b64_tr_b16 v[148:149], v7 offset:8192
    v_mfma_f32_16x16x32_bf16 a[44:47], v[32:35], v[164:167], a[44:47]
    ds_read_b64_tr_b16 v[150:151], v7 offset:8448
    v_mfma_f32_16x16x32_bf16 a[40:43], v[36:39], v[168:171], a[40:43]
    ds_read_b64_tr_b16 v[152:153], v6 offset:10240
    v_mfma_f32_16x16x32_bf16 a[44:47], v[36:39], v[172:175], a[44:47]
    ds_read_b64_tr_b16 v[154:155], v6 offset:10496
    v_mfma_f32_16x16x32_bf16 a[48:51], v[40:43], v[160:163], a[48:51]
    ds_read_b64_tr_b16 v[156:157], v7 offset:10240
    v_mfma_f32_16x16x32_bf16 a[52:55], v[40:43], v[164:167], a[52:55]
    ds_read_b64_tr_b16 v[158:159], v7 offset:10496
    v_mfma_f32_16x16x32_bf16 a[48:51], v[44:47], v[168:171], a[48:51]
    s_add_u32 m0, s28, 16896
    v_mfma_f32_16x16x32_bf16 a[52:55], v[44:47], v[172:175], a[52:55]
    s_waitcnt vmcnt(12)
    buffer_load_dwordx4 v8, s[12:15], s30 offen offset:1536 lds
    v_mfma_f32_16x16x32_bf16 a[56:59], v[48:51], v[160:163], a[56:59]
    s_add_u32 m0, s28, 17920
    v_mfma_f32_16x16x32_bf16 a[60:63], v[48:51], v[164:167], a[60:63]
    buffer_load_dwordx4 v9, s[12:15], s30 offen offset:1536 lds
    v_mfma_f32_16x16x32_bf16 a[56:59], v[52:55], v[168:171], a[56:59]
    v_mfma_f32_16x16x32_bf16 a[60:63], v[52:55], v[172:175], a[60:63]
    s_waitcnt lgkmcnt(0)
    v_mfma_f32_16x16x32_bf16 a[0:3], v[64:67], v[144:147], a[0:3]
    v_mfma_f32_16x16x32_bf16 a[4:7], v[64:67], v[148:151], a[4:7]
    v_mfma_f32_16x16x32_bf16 a[0:3], v[68:71], v[152:155], a[0:3]
    v_mfma_f32_16x16x32_bf16 a[4:7], v[68:71], v[156:159], a[4:7]
    v_mov_b32_dpp v64, v64 row_shl:1 row_mask:0xf bank_mask:0xf
    v_mfma_f32_16x16x32_bf16 a[8:11], v[72:75], v[144:147], a[8:11]
    v_mov_b32_dpp v65, v65 row_shl:1 row_mask:0xf bank_mask:0xf
    v_mfma_f32_16x16x32_bf16 a[12:15], v[72:75], v[148:151], a[12:15]
    v_mov_b32_dpp v66, v66 row_shl:1 row_mask:0xf bank_mask:0xf
    v_mfma_f32_16x16x32_bf16 a[8:11], v[76:79], v[152:155], a[8:11]
    v_mov_b32_dpp v67, v67 row_shl:1 row_mask:0xf bank_mask:0xf
    v_mfma_f32_16x16x32_bf16 a[12:15], v[76:79], v[156:159], a[12:15]
    v_mov_b32_dpp v68, v68 row_shl:1 row_mask:0xf bank_mask:0xf
    v_mfma_f32_16x16x32_bf16 a[16:19], v[16:19], v[144:147], a[16:19]
    v_mov_b32_dpp v69, v69 row_shl:1 row_mask:0xf bank_mask:0xf
    v_mfma_f32_16x16x32_bf16 a[20:23], v[16:19], v[148:151], a[20:23]
    v_mov_b32_dpp v70, v70 row_shl:1 row_mask:0xf bank_mask:0xf
    v_mfma_f32_16x16x32_bf16 a[16:19], v[20:23], v[152:155], a[16:19]
    v_mov_b32_dpp v71, v71 row_shl:1 row_mask:0xf bank_mask:0xf
    v_mfma_f32_16x16x32_bf16 a[20:23], v[20:23], v[156:159], a[20:23]
    s_mov_b64 exec, s[46:47]
    buffer_load_dwordx4 v[64:67], v1, s[12:15], s33 offen offset:2048
    buffer_load_dwordx4 v[68:71], v1, s[12:15], s33 offen offset:2112
    s_mov_b64 exec, -1
    v_mfma_f32_16x16x32_bf16 a[24:27], v[24:27], v[144:147], a[24:27]
    v_mfma_f32_16x16x32_bf16 a[28:31], v[24:27], v[148:151], a[28:31]
    s_add_u32 s37, s36, 2621440
    s_add_u32 m0, s28, 8192
    v_mfma_f32_16x16x32_bf16 a[24:27], v[28:31], v[152:155], a[24:27]
    buffer_load_dwordx4 v2, s[16:19], s37 offen offset:0 lds
    v_mfma_f32_16x16x32_bf16 a[28:31], v[28:31], v[156:159], a[28:31]
    buffer_load_dwordx4 v3, s[16:19], s37 offen offset:1024 lds
    v_mfma_f32_16x16x32_bf16 a[32:35], v[32:35], v[144:147], a[32:35]
    buffer_load_dwordx4 v4, s[16:19], s37 offen offset:2048 lds
    v_mfma_f32_16x16x32_bf16 a[36:39], v[32:35], v[148:151], a[36:39]
    buffer_load_dwordx4 v5, s[16:19], s37 offen offset:3072 lds
    v_mfma_f32_16x16x32_bf16 a[32:35], v[36:39], v[152:155], a[32:35]
    ds_read_b64_tr_b16 v[160:161], v6 offset:12288
    v_mfma_f32_16x16x32_bf16 a[36:39], v[36:39], v[156:159], a[36:39]
    ds_read_b64_tr_b16 v[162:163], v6 offset:12544
    v_mfma_f32_16x16x32_bf16 a[40:43], v[40:43], v[144:147], a[40:43]
    ds_read_b64_tr_b16 v[164:165], v7 offset:12288
    v_mfma_f32_16x16x32_bf16 a[44:47], v[40:43], v[148:151], a[44:47]
    ds_read_b64_tr_b16 v[166:167], v7 offset:12544
    v_mfma_f32_16x16x32_bf16 a[40:43], v[44:47], v[152:155], a[40:43]
    ds_read_b64_tr_b16 v[168:169], v6 offset:14336
    v_mfma_f32_16x16x32_bf16 a[44:47], v[44:47], v[156:159], a[44:47]
    ds_read_b64_tr_b16 v[170:171], v6 offset:14592
    v_mfma_f32_16x16x32_bf16 a[48:51], v[48:51], v[144:147], a[48:51]
    ds_read_b64_tr_b16 v[172:173], v7 offset:14336
    v_mfma_f32_16x16x32_bf16 a[52:55], v[48:51], v[148:151], a[52:55]
    ds_read_b64_tr_b16 v[174:175], v7 offset:14592
    v_mfma_f32_16x16x32_bf16 a[48:51], v[52:55], v[152:155], a[48:51]
    s_add_u32 m0, s28, 17920
    v_mfma_f32_16x16x32_bf16 a[52:55], v[52:55], v[156:159], a[52:55]
    s_waitcnt vmcnt(12)
    buffer_load_dwordx4 v8, s[12:15], s30 offen offset:2560 lds
    v_mfma_f32_16x16x32_bf16 a[56:59], v[56:59], v[144:147], a[56:59]
    s_add_u32 m0, s28, 18944
    v_mfma_f32_16x16x32_bf16 a[60:63], v[56:59], v[148:151], a[60:63]
    buffer_load_dwordx4 v9, s[12:15], s30 offen offset:2560 lds
    v_mfma_f32_16x16x32_bf16 a[56:59], v[60:63], v[152:155], a[56:59]
    v_mfma_f32_16x16x32_bf16 a[60:63], v[60:63], v[156:159], a[60:63]
    s_waitcnt lgkmcnt(0)
    v_mfma_f32_16x16x32_bf16 a[0:3], v[72:75], v[160:163], a[0:3]
    v_mfma_f32_16x16x32_bf16 a[4:7], v[72:75], v[164:167], a[4:7]
    v_mfma_f32_16x16x32_bf16 a[0:3], v[76:79], v[168:171], a[0:3]
    v_mfma_f32_16x16x32_bf16 a[4:7], v[76:79], v[172:175], a[4:7]
    v_mov_b32_dpp v72, v72 row_shl:1 row_mask:0xf bank_mask:0xf
    v_mfma_f32_16x16x32_bf16 a[8:11], v[16:19], v[160:163], a[8:11]
    v_mov_b32_dpp v73, v73 row_shl:1 row_mask:0xf bank_mask:0xf
    v_mfma_f32_16x16x32_bf16 a[12:15], v[16:19], v[164:167], a[12:15]
    v_mov_b32_dpp v74, v74 row_shl:1 row_mask:0xf bank_mask:0xf
    v_mfma_f32_16x16x32_bf16 a[8:11], v[20:23], v[168:171], a[8:11]
    v_mov_b32_dpp v75, v75 row_shl:1 row_mask:0xf bank_mask:0xf
    v_mfma_f32_16x16x32_bf16 a[12:15], v[20:23], v[172:175], a[12:15]
    v_mov_b32_dpp v76, v76 row_shl:1 row_mask:0xf bank_mask:0xf
    v_mfma_f32_16x16x32_bf16 a[16:19], v[24:27], v[160:163], a[16:19]
    v_mov_b32_dpp v77, v77 row_shl:1 row_mask:0xf bank_mask:0xf
    v_mfma_f32_16x16x32_bf16 a[20:23], v[24:27], v[164:167], a[20:23]
    v_mov_b32_dpp v78, v78 row_shl:1 row_mask:0xf bank_mask:0xf
    v_mfma_f32_16x16x32_bf16 a[16:19], v[28:31], v[168:171], a[16:19]
    v_mov_b32_dpp v79, v79 row_shl:1 row_mask:0xf bank_mask:0xf
    v_mfma_f32_16x16x32_bf16 a[20:23], v[28:31], v[172:175], a[20:23]
    s_mov_b64 exec, s[46:47]
    buffer_load_dwordx4 v[72:75], v1, s[12:15], s33 offen offset:3072
    buffer_load_dwordx4 v[76:79], v1, s[12:15], s33 offen offset:3136
    s_mov_b64 exec, -1
    v_mfma_f32_16x16x32_bf16 a[24:27], v[32:35], v[160:163], a[24:27]
    v_mfma_f32_16x16x32_bf16 a[28:31], v[32:35], v[164:167], a[28:31]
    s_add_u32 s37, s36, 2883584
    s_add_u32 m0, s28, 12288
    v_mfma_f32_16x16x32_bf16 a[24:27], v[36:39], v[168:171], a[24:27]
    buffer_load_dwordx4 v2, s[16:19], s37 offen offset:0 lds
    v_mfma_f32_16x16x32_bf16 a[28:31], v[36:39], v[172:175], a[28:31]
    buffer_load_dwordx4 v3, s[16:19], s37 offen offset:1024 lds
    v_mfma_f32_16x16x32_bf16 a[32:35], v[40:43], v[160:163], a[32:35]
    buffer_load_dwordx4 v4, s[16:19], s37 offen offset:2048 lds
    v_mfma_f32_16x16x32_bf16 a[36:39], v[40:43], v[164:167], a[36:39]
    buffer_load_dwordx4 v5, s[16:19], s37 offen offset:3072 lds
    v_mfma_f32_16x16x32_bf16 a[32:35], v[44:47], v[168:171], a[32:35]
    ds_read_b64_tr_b16 v[144:145], v6 offset:0
    v_mfma_f32_16x16x32_bf16 a[36:39], v[44:47], v[172:175], a[36:39]
    ds_read_b64_tr_b16 v[146:147], v6 offset:256
    v_mfma_f32_16x16x32_bf16 a[40:43], v[48:51], v[160:163], a[40:43]
    ds_read_b64_tr_b16 v[148:149], v7 offset:0
    v_mfma_f32_16x16x32_bf16 a[44:47], v[48:51], v[164:167], a[44:47]
    ds_read_b64_tr_b16 v[150:151], v7 offset:256
    v_mfma_f32_16x16x32_bf16 a[40:43], v[52:55], v[168:171], a[40:43]
    ds_read_b64_tr_b16 v[152:153], v6 offset:2048
    v_mfma_f32_16x16x32_bf16 a[44:47], v[52:55], v[172:175], a[44:47]
    ds_read_b64_tr_b16 v[154:155], v6 offset:2304
    v_mfma_f32_16x16x32_bf16 a[48:51], v[56:59], v[160:163], a[48:51]
    ds_read_b64_tr_b16 v[156:157], v7 offset:2048
    v_mfma_f32_16x16x32_bf16 a[52:55], v[56:59], v[164:167], a[52:55]
    ds_read_b64_tr_b16 v[158:159], v7 offset:2304
    v_mfma_f32_16x16x32_bf16 a[48:51], v[60:63], v[168:171], a[48:51]
    s_add_u32 m0, s28, 18944
    v_mfma_f32_16x16x32_bf16 a[52:55], v[60:63], v[172:175], a[52:55]
    s_waitcnt vmcnt(12)
    buffer_load_dwordx4 v8, s[12:15], s30 offen offset:3584 lds
    v_mfma_f32_16x16x32_bf16 a[56:59], v[64:67], v[160:163], a[56:59]
    s_add_u32 m0, s28, 19968
    v_mfma_f32_16x16x32_bf16 a[60:63], v[64:67], v[164:167], a[60:63]
    buffer_load_dwordx4 v9, s[12:15], s30 offen offset:3584 lds
    v_mfma_f32_16x16x32_bf16 a[56:59], v[68:71], v[168:171], a[56:59]
    v_mfma_f32_16x16x32_bf16 a[60:63], v[68:71], v[172:175], a[60:63]
    s_waitcnt lgkmcnt(0)
    v_mfma_f32_16x16x32_bf16 a[0:3], v[16:19], v[144:147], a[0:3]
    v_mfma_f32_16x16x32_bf16 a[4:7], v[16:19], v[148:151], a[4:7]
    v_mfma_f32_16x16x32_bf16 a[0:3], v[20:23], v[152:155], a[0:3]
    v_mfma_f32_16x16x32_bf16 a[4:7], v[20:23], v[156:159], a[4:7]
    v_mov_b32_dpp v16, v16 row_shl:1 row_mask:0xf bank_mask:0xf
    v_mfma_f32_16x16x32_bf16 a[8:11], v[24:27], v[144:147], a[8:11]
    v_mov_b32_dpp v17, v17 row_shl:1 row_mask:0xf bank_mask:0xf
    v_mfma_f32_16x16x32_bf16 a[12:15], v[24:27], v[148:151], a[12:15]
    v_mov_b32_dpp v18, v18 row_shl:1 row_mask:0xf bank_mask:0xf
    v_mfma_f32_16x16x32_bf16 a[8:11], v[28:31], v[152:155], a[8:11]
    v_mov_b32_dpp v19, v19 row_shl:1 row_mask:0xf bank_mask:0xf
    v_mfma_f32_16x16x32_bf16 a[12:15], v[28:31], v[156:159], a[12:15]
    v_mov_b32_dpp v20, v20 row_shl:1 row_mask:0xf bank_mask:0xf
    v_mfma_f32_16x16x32_bf16 a[16:19], v[32:35], v[144:147], a[16:19]
    v_mov_b32_dpp v21, v21 row_shl:1 row_mask:0xf bank_mask:0xf
    v_mfma_f32_16x16x32_bf16 a[20:23], v[32:35], v[148:151], a[20:23]
    v_mov_b32_dpp v22, v22 row_shl:1 row_mask:0xf bank_mask:0xf
    v_mfma_f32_16x16x32_bf16 a[16:19], v[36:39], v[152:155], a[16:19]
    v_mov_b32_dpp v23, v23 row_shl:1 row_mask:0xf bank_mask:0xf
    v_mfma_f32_16x16x32_bf16 a[20:23], v[36:39], v[156:159], a[20:23]
    s_mov_b64 exec, s[46:47]
    buffer_load_dwordx4 v[16:19], v1, s[12:15], s34 offen offset:0
    buffer_load_dwordx4 v[20:23], v1, s[12:15], s34 offen offset:64
    s_mov_b64 exec, -1
    v_mfma_f32_16x16x32_bf16 a[24:27], v[40:43], v[144:147], a[24:27]
    v_mfma_f32_16x16x32_bf16 a[28:31], v[40:43], v[148:151], a[28:31]
    s_add_u32 s37, s36, 3145728
    s_add_u32 m0, s28, 0
    v_mfma_f32_16x16x32_bf16 a[24:27], v[44:47], v[152:155], a[24:27]
    buffer_load_dwordx4 v2, s[16:19], s37 offen offset:0 lds
    v_mfma_f32_16x16x32_bf16 a[28:31], v[44:47], v[156:159], a[28:31]
    buffer_load_dwordx4 v3, s[16:19], s37 offen offset:1024 lds
    v_mfma_f32_16x16x32_bf16 a[32:35], v[48:51], v[144:147], a[32:35]
    buffer_load_dwordx4 v4, s[16:19], s37 offen offset:2048 lds
    v_mfma_f32_16x16x32_bf16 a[36:39], v[48:51], v[148:151], a[36:39]
    buffer_load_dwordx4 v5, s[16:19], s37 offen offset:3072 lds
    v_mfma_f32_16x16x32_bf16 a[32:35], v[52:55], v[152:155], a[32:35]
    ds_read_b64_tr_b16 v[160:161], v6 offset:4096
    v_mfma_f32_16x16x32_bf16 a[36:39], v[52:55], v[156:159], a[36:39]
    ds_read_b64_tr_b16 v[162:163], v6 offset:4352
    v_mfma_f32_16x16x32_bf16 a[40:43], v[56:59], v[144:147], a[40:43]
    ds_read_b64_tr_b16 v[164:165], v7 offset:4096
    v_mfma_f32_16x16x32_bf16 a[44:47], v[56:59], v[148:151], a[44:47]
    ds_read_b64_tr_b16 v[166:167], v7 offset:4352
    v_mfma_f32_16x16x32_bf16 a[40:43], v[60:63], v[152:155], a[40:43]
    ds_read_b64_tr_b16 v[168:169], v6 offset:6144
    v_mfma_f32_16x16x32_bf16 a[44:47], v[60:63], v[156:159], a[44:47]
    ds_read_b64_tr_b16 v[170:171], v6 offset:6400
    v_mfma_f32_16x16x32_bf16 a[48:51], v[64:67], v[144:147], a[48:51]
    ds_read_b64_tr_b16 v[172:173], v7 offset:6144
    ds_read_b128 v[80:83], v10 offset:0
    ds_read_b128 v[84:87], v11 offset:0
    v_mfma_f32_16x16x32_bf16 a[52:55], v[64:67], v[148:151], a[52:55]
    ds_read_b64_tr_b16 v[174:175], v7 offset:6400
    v_mfma_f32_16x16x32_bf16 a[48:51], v[68:71], v[152:155], a[48:51]
    s_add_u32 m0, s28, 24064
    v_mfma_f32_16x16x32_bf16 a[52:55], v[68:71], v[156:159], a[52:55]
    s_waitcnt vmcnt(12)
    buffer_load_dwordx4 v8, s[12:15], s31 offen offset:512 lds
    v_mfma_f32_16x16x32_bf16 a[56:59], v[72:75], v[144:147], a[56:59]
    s_add_u32 m0, s28, 25088
    v_mfma_f32_16x16x32_bf16 a[60:63], v[72:75], v[148:151], a[60:63]
    buffer_load_dwordx4 v9, s[12:15], s31 offen offset:512 lds
    v_mfma_f32_16x16x32_bf16 a[56:59], v[76:79], v[152:155], a[56:59]
    v_mfma_f32_16x16x32_bf16 a[60:63], v[76:79], v[156:159], a[60:63]
    s_waitcnt lgkmcnt(0)
    v_mfma_f32_16x16x32_bf16 a[0:3], v[24:27], v[160:163], a[0:3]
    v_mfma_f32_16x16x32_bf16 a[4:7], v[24:27], v[164:167], a[4:7]
    v_mfma_f32_16x16x32_bf16 a[0:3], v[28:31], v[168:171], a[0:3]
    v_mfma_f32_16x16x32_bf16 a[4:7], v[28:31], v[172:175], a[4:7]
    v_mov_b32_dpp v24, v24 row_shl:1 row_mask:0xf bank_mask:0xf
    v_mfma_f32_16x16x32_bf16 a[8:11], v[32:35], v[160:163], a[8:11]
    v_mov_b32_dpp v25, v25 row_shl:1 row_mask:0xf bank_mask:0xf
    v_mfma_f32_16x16x32_bf16 a[12:15], v[32:35], v[164:167], a[12:15]
    v_mov_b32_dpp v26, v26 row_shl:1 row_mask:0xf bank_mask:0xf
    v_mfma_f32_16x16x32_bf16 a[8:11], v[36:39], v[168:171], a[8:11]
    v_mov_b32_dpp v27, v27 row_shl:1 row_mask:0xf bank_mask:0xf
    v_mfma_f32_16x16x32_bf16 a[12:15], v[36:39], v[172:175], a[12:15]
    v_mov_b32_dpp v28, v28 row_shl:1 row_mask:0xf bank_mask:0xf
    v_mfma_f32_16x16x32_bf16 a[16:19], v[40:43], v[160:163], a[16:19]
    v_mov_b32_dpp v29, v29 row_shl:1 row_mask:0xf bank_mask:0xf
    v_mfma_f32_16x16x32_bf16 a[20:23], v[40:43], v[164:167], a[20:23]
    v_mov_b32_dpp v30, v30 row_shl:1 row_mask:0xf bank_mask:0xf
    v_mfma_f32_16x16x32_bf16 a[16:19], v[44:47], v[168:171], a[16:19]
    v_mov_b32_dpp v31, v31 row_shl:1 row_mask:0xf bank_mask:0xf
    v_mfma_f32_16x16x32_bf16 a[20:23], v[44:47], v[172:175], a[20:23]
    s_mov_b64 exec, s[46:47]
    buffer_load_dwordx4 v[24:27], v1, s[12:15], s34 offen offset:1024
    buffer_load_dwordx4 v[28:31], v1, s[12:15], s34 offen offset:1088
    s_mov_b64 exec, -1
    v_mfma_f32_16x16x32_bf16 a[24:27], v[48:51], v[160:163], a[24:27]
    v_mfma_f32_16x16x32_bf16 a[28:31], v[48:51], v[164:167], a[28:31]
    s_add_u32 s37, s36, 3407872
    s_add_u32 m0, s28, 4096
    v_mfma_f32_16x16x32_bf16 a[24:27], v[52:55], v[168:171], a[24:27]
    buffer_load_dwordx4 v2, s[16:19], s37 offen offset:0 lds
    v_mfma_f32_16x16x32_bf16 a[28:31], v[52:55], v[172:175], a[28:31]
    buffer_load_dwordx4 v3, s[16:19], s37 offen offset:1024 lds
    v_mfma_f32_16x16x32_bf16 a[32:35], v[56:59], v[160:163], a[32:35]
    buffer_load_dwordx4 v4, s[16:19], s37 offen offset:2048 lds
    v_mfma_f32_16x16x32_bf16 a[36:39], v[56:59], v[164:167], a[36:39]
    buffer_load_dwordx4 v5, s[16:19], s37 offen offset:3072 lds
    v_mfma_f32_16x16x32_bf16 a[32:35], v[60:63], v[168:171], a[32:35]
    ds_read_b64_tr_b16 v[144:145], v6 offset:8192
    v_mfma_f32_16x16x32_bf16 a[36:39], v[60:63], v[172:175], a[36:39]
    ds_read_b64_tr_b16 v[146:147], v6 offset:8448
    v_mfma_f32_16x16x32_bf16 a[40:43], v[64:67], v[160:163], a[40:43]
    ds_read_b64_tr_b16 v[148:149], v7 offset:8192
    v_mfma_f32_16x16x32_bf16 a[44:47], v[64:67], v[164:167], a[44:47]
    ds_read_b64_tr_b16 v[150:151], v7 offset:8448
    v_mfma_f32_16x16x32_bf16 a[40:43], v[68:71], v[168:171], a[40:43]
    ds_read_b64_tr_b16 v[152:153], v6 offset:10240
    v_mfma_f32_16x16x32_bf16 a[44:47], v[68:71], v[172:175], a[44:47]
    ds_read_b64_tr_b16 v[154:155], v6 offset:10496
    v_mfma_f32_16x16x32_bf16 a[48:51], v[72:75], v[160:163], a[48:51]
    ds_read_b64_tr_b16 v[156:157], v7 offset:10240
    ds_read_b128 v[88:91], v10 offset:2048
    ds_read_b128 v[92:95], v11 offset:2048
    v_mfma_f32_16x16x32_bf16 a[52:55], v[72:75], v[164:167], a[52:55]
    ds_read_b64_tr_b16 v[158:159], v7 offset:10496
    v_mfma_f32_16x16x32_bf16 a[48:51], v[76:79], v[168:171], a[48:51]
    s_add_u32 m0, s28, 25088
    v_mfma_f32_16x16x32_bf16 a[52:55], v[76:79], v[172:175], a[52:55]
    s_waitcnt vmcnt(12)
    buffer_load_dwordx4 v8, s[12:15], s31 offen offset:1536 lds
    v_mfma_f32_16x16x32_bf16 a[56:59], v[16:19], v[160:163], a[56:59]
    s_add_u32 m0, s28, 26112
    v_mfma_f32_16x16x32_bf16 a[60:63], v[16:19], v[164:167], a[60:63]
    buffer_load_dwordx4 v9, s[12:15], s31 offen offset:1536 lds
    v_mfma_f32_16x16x32_bf16 a[56:59], v[20:23], v[168:171], a[56:59]
    v_mfma_f32_16x16x32_bf16 a[60:63], v[20:23], v[172:175], a[60:63]
    s_waitcnt lgkmcnt(0)
    v_mfma_f32_16x16x32_bf16 a[0:3], v[32:35], v[144:147], a[0:3]
    v_mfma_f32_16x16x32_bf16 a[4:7], v[32:35], v[148:151], a[4:7]
    v_mfma_f32_16x16x32_bf16 a[0:3], v[36:39], v[152:155], a[0:3]
    v_mfma_f32_16x16x32_bf16 a[4:7], v[36:39], v[156:159], a[4:7]
    v_mov_b32_dpp v32, v32 row_shl:1 row_mask:0xf bank_mask:0xf
    v_mfma_f32_16x16x32_bf16 a[8:11], v[40:43], v[144:147], a[8:11]
    v_mov_b32_dpp v33, v33 row_shl:1 row_mask:0xf bank_mask:0xf
    v_mfma_f32_16x16x32_bf16 a[12:15], v[40:43], v[148:151], a[12:15]
    v_mov_b32_dpp v34, v34 row_shl:1 row_mask:0xf bank_mask:0xf
    v_mfma_f32_16x16x32_bf16 a[8:11], v[44:47], v[152:155], a[8:11]
    v_mov_b32_dpp v35, v35 row_shl:1 row_mask:0xf bank_mask:0xf
    v_mfma_f32_16x16x32_bf16 a[12:15], v[44:47], v[156:159], a[12:15]
    v_mov_b32_dpp v36, v36 row_shl:1 row_mask:0xf bank_mask:0xf
    v_mfma_f32_16x16x32_bf16 a[16:19], v[48:51], v[144:147], a[16:19]
    v_mov_b32_dpp v37, v37 row_shl:1 row_mask:0xf bank_mask:0xf
    v_mfma_f32_16x16x32_bf16 a[20:23], v[48:51], v[148:151], a[20:23]
    v_mov_b32_dpp v38, v38 row_shl:1 row_mask:0xf bank_mask:0xf
    v_mfma_f32_16x16x32_bf16 a[16:19], v[52:55], v[152:155], a[16:19]
    v_mov_b32_dpp v39, v39 row_shl:1 row_mask:0xf bank_mask:0xf
    v_mfma_f32_16x16x32_bf16 a[20:23], v[52:55], v[156:159], a[20:23]
    s_mov_b64 exec, s[46:47]
    buffer_load_dwordx4 v[32:35], v1, s[12:15], s34 offen offset:2048
    buffer_load_dwordx4 v[36:39], v1, s[12:15], s34 offen offset:2112
    s_mov_b64 exec, -1
    v_mfma_f32_16x16x32_bf16 a[24:27], v[56:59], v[144:147], a[24:27]
    v_mfma_f32_16x16x32_bf16 a[28:31], v[56:59], v[148:151], a[28:31]
    s_add_u32 s37, s36, 3670016
    s_add_u32 m0, s28, 8192
    v_mfma_f32_16x16x32_bf16 a[24:27], v[60:63], v[152:155], a[24:27]
    buffer_load_dwordx4 v2, s[16:19], s37 offen offset:0 lds
    v_mfma_f32_16x16x32_bf16 a[28:31], v[60:63], v[156:159], a[28:31]
    buffer_load_dwordx4 v3, s[16:19], s37 offen offset:1024 lds
    v_mfma_f32_16x16x32_bf16 a[32:35], v[64:67], v[144:147], a[32:35]
    buffer_load_dwordx4 v4, s[16:19], s37 offen offset:2048 lds
    v_mfma_f32_16x16x32_bf16 a[36:39], v[64:67], v[148:151], a[36:39]
    buffer_load_dwordx4 v5, s[16:19], s37 offen offset:3072 lds
    v_mfma_f32_16x16x32_bf16 a[32:35], v[68:71], v[152:155], a[32:35]
    ds_read_b64_tr_b16 v[160:161], v6 offset:12288
    v_mfma_f32_16x16x32_bf16 a[36:39], v[68:71], v[156:159], a[36:39]
    ds_read_b64_tr_b16 v[162:163], v6 offset:12544
    v_mfma_f32_16x16x32_bf16 a[40:43], v[72:75], v[144:147], a[40:43]
    ds_read_b64_tr_b16 v[164:165], v7 offset:12288
    v_mfma_f32_16x16x32_bf16 a[44:47], v[72:75], v[148:151], a[44:47]
    ds_read_b64_tr_b16 v[166:167], v7 offset:12544
    v_mfma_f32_16x16x32_bf16 a[40:43], v[76:79], v[152:155], a[40:43]
    ds_read_b64_tr_b16 v[168:169], v6 offset:14336
    v_mfma_f32_16x16x32_bf16 a[44:47], v[76:79], v[156:159], a[44:47]
    ds_read_b64_tr_b16 v[170:171], v6 offset:14592
    v_mfma_f32_16x16x32_bf16 a[48:51], v[16:19], v[144:147], a[48:51]
    ds_read_b64_tr_b16 v[172:173], v7 offset:14336
    ds_read_b128 v[96:99], v10 offset:4096
    ds_read_b128 v[100:103], v11 offset:4096
    v_mfma_f32_16x16x32_bf16 a[52:55], v[16:19], v[148:151], a[52:55]
    ds_read_b64_tr_b16 v[174:175], v7 offset:14592
    v_mfma_f32_16x16x32_bf16 a[48:51], v[20:23], v[152:155], a[48:51]
    s_add_u32 m0, s28, 26112
    v_mfma_f32_16x16x32_bf16 a[52:55], v[20:23], v[156:159], a[52:55]
    s_waitcnt vmcnt(12)
    buffer_load_dwordx4 v8, s[12:15], s31 offen offset:2560 lds
    v_mfma_f32_16x16x32_bf16 a[56:59], v[24:27], v[144:147], a[56:59]
    s_add_u32 m0, s28, 27136
    v_mfma_f32_16x16x32_bf16 a[60:63], v[24:27], v[148:151], a[60:63]
    buffer_load_dwordx4 v9, s[12:15], s31 offen offset:2560 lds
    v_mfma_f32_16x16x32_bf16 a[56:59], v[28:31], v[152:155], a[56:59]
    v_mfma_f32_16x16x32_bf16 a[60:63], v[28:31], v[156:159], a[60:63]
    s_waitcnt lgkmcnt(0)
    v_mfma_f32_16x16x32_bf16 a[0:3], v[40:43], v[160:163], a[0:3]
    v_mfma_f32_16x16x32_bf16 a[4:7], v[40:43], v[164:167], a[4:7]
    v_mfma_f32_16x16x32_bf16 a[0:3], v[44:47], v[168:171], a[0:3]
    v_mfma_f32_16x16x32_bf16 a[4:7], v[44:47], v[172:175], a[4:7]
    v_mov_b32_dpp v40, v40 row_shl:1 row_mask:0xf bank_mask:0xf
    v_mfma_f32_16x16x32_bf16 a[8:11], v[48:51], v[160:163], a[8:11]
    v_mov_b32_dpp v41, v41 row_shl:1 row_mask:0xf bank_mask:0xf
    v_mfma_f32_16x16x32_bf16 a[12:15], v[48:51], v[164:167], a[12:15]
    v_mov_b32_dpp v42, v42 row_shl:1 row_mask:0xf bank_mask:0xf
    v_mfma_f32_16x16x32_bf16 a[8:11], v[52:55], v[168:171], a[8:11]
    v_mov_b32_dpp v43, v43 row_shl:1 row_mask:0xf bank_mask:0xf
    v_mfma_f32_16x16x32_bf16 a[12:15], v[52:55], v[172:175], a[12:15]
    v_mov_b32_dpp v44, v44 row_shl:1 row_mask:0xf bank_mask:0xf
    v_mfma_f32_16x16x32_bf16 a[16:19], v[56:59], v[160:163], a[16:19]
    v_mov_b32_dpp v45, v45 row_shl:1 row_mask:0xf bank_mask:0xf
    v_mfma_f32_16x16x32_bf16 a[20:23], v[56:59], v[164:167], a[20:23]
    v_mov_b32_dpp v46, v46 row_shl:1 row_mask:0xf bank_mask:0xf
    v_mfma_f32_16x16x32_bf16 a[16:19], v[60:63], v[168:171], a[16:19]
    v_mov_b32_dpp v47, v47 row_shl:1 row_mask:0xf bank_mask:0xf
    v_mfma_f32_16x16x32_bf16 a[20:23], v[60:63], v[172:175], a[20:23]
    s_mov_b64 exec, s[46:47]
    buffer_load_dwordx4 v[40:43], v1, s[12:15], s34 offen offset:3072
    buffer_load_dwordx4 v[44:47], v1, s[12:15], s34 offen offset:3136
    s_mov_b64 exec, -1
    v_mfma_f32_16x16x32_bf16 a[24:27], v[64:67], v[160:163], a[24:27]
    v_mfma_f32_16x16x32_bf16 a[28:31], v[64:67], v[164:167], a[28:31]
    s_add_u32 s37, s36, 3932160
    s_add_u32 m0, s28, 12288
    v_mfma_f32_16x16x32_bf16 a[24:27], v[68:71], v[168:171], a[24:27]
    buffer_load_dwordx4 v2, s[16:19], s37 offen offset:0 lds
    v_mfma_f32_16x16x32_bf16 a[28:31], v[68:71], v[172:175], a[28:31]
    buffer_load_dwordx4 v3, s[16:19], s37 offen offset:1024 lds
    v_mfma_f32_16x16x32_bf16 a[32:35], v[72:75], v[160:163], a[32:35]
    buffer_load_dwordx4 v4, s[16:19], s37 offen offset:2048 lds
    v_mfma_f32_16x16x32_bf16 a[36:39], v[72:75], v[164:167], a[36:39]
    buffer_load_dwordx4 v5, s[16:19], s37 offen offset:3072 lds
    v_mfma_f32_16x16x32_bf16 a[32:35], v[76:79], v[168:171], a[32:35]
    ds_read_b64_tr_b16 v[144:145], v6 offset:0
    v_mfma_f32_16x16x32_bf16 a[36:39], v[76:79], v[172:175], a[36:39]
    ds_read_b64_tr_b16 v[146:147], v6 offset:256
    v_mfma_f32_16x16x32_bf16 a[40:43], v[16:19], v[160:163], a[40:43]
    ds_read_b64_tr_b16 v[148:149], v7 offset:0
    v_mfma_f32_16x16x32_bf16 a[44:47], v[16:19], v[164:167], a[44:47]
    ds_read_b64_tr_b16 v[150:151], v7 offset:256
    v_mfma_f32_16x16x32_bf16 a[40:43], v[20:23], v[168:171], a[40:43]
    ds_read_b64_tr_b16 v[152:153], v6 offset:2048
    v_mfma_f32_16x16x32_bf16 a[44:47], v[20:23], v[172:175], a[44:47]
    ds_read_b64_tr_b16 v[154:155], v6 offset:2304
    v_mfma_f32_16x16x32_bf16 a[48:51], v[24:27], v[160:163], a[48:51]
    ds_read_b64_tr_b16 v[156:157], v7 offset:2048
    ds_read_b128 v[104:107], v10 offset:6144
    ds_read_b128 v[108:111], v11 offset:6144
    v_mfma_f32_16x16x32_bf16 a[52:55], v[24:27], v[164:167], a[52:55]
    ds_read_b64_tr_b16 v[158:159], v7 offset:2304
    v_mfma_f32_16x16x32_bf16 a[48:51], v[28:31], v[168:171], a[48:51]
    s_add_u32 m0, s28, 27136
    v_mfma_f32_16x16x32_bf16 a[52:55], v[28:31], v[172:175], a[52:55]
    s_waitcnt vmcnt(12)
    buffer_load_dwordx4 v8, s[12:15], s31 offen offset:3584 lds
    v_mfma_f32_16x16x32_bf16 a[56:59], v[32:35], v[160:163], a[56:59]
    s_add_u32 m0, s28, 28160
    v_mfma_f32_16x16x32_bf16 a[60:63], v[32:35], v[164:167], a[60:63]
    buffer_load_dwordx4 v9, s[12:15], s31 offen offset:3584 lds
    v_mfma_f32_16x16x32_bf16 a[56:59], v[36:39], v[168:171], a[56:59]
    v_mfma_f32_16x16x32_bf16 a[60:63], v[36:39], v[172:175], a[60:63]
    s_waitcnt lgkmcnt(0)
    v_mfma_f32_16x16x32_bf16 a[0:3], v[48:51], v[144:147], a[0:3]
    v_mfma_f32_16x16x32_bf16 a[4:7], v[48:51], v[148:151], a[4:7]
    v_mfma_f32_16x16x32_bf16 a[0:3], v[52:55], v[152:155], a[0:3]
    v_mfma_f32_16x16x32_bf16 a[4:7], v[52:55], v[156:159], a[4:7]
    v_mov_b32_dpp v48, v48 row_shl:1 row_mask:0xf bank_mask:0xf
    v_mfma_f32_16x16x32_bf16 a[8:11], v[56:59], v[144:147], a[8:11]
    v_mov_b32_dpp v49, v49 row_shl:1 row_mask:0xf bank_mask:0xf
    v_mfma_f32_16x16x32_bf16 a[12:15], v[56:59], v[148:151], a[12:15]
    v_mov_b32_dpp v50, v50 row_shl:1 row_mask:0xf bank_mask:0xf
    v_mfma_f32_16x16x32_bf16 a[8:11], v[60:63], v[152:155], a[8:11]
    v_mov_b32_dpp v51, v51 row_shl:1 row_mask:0xf bank_mask:0xf
    v_mfma_f32_16x16x32_bf16 a[12:15], v[60:63], v[156:159], a[12:15]
    v_mov_b32_dpp v52, v52 row_shl:1 row_mask:0xf bank_mask:0xf
    v_mfma_f32_16x16x32_bf16 a[16:19], v[64:67], v[144:147], a[16:19]
    v_mov_b32_dpp v53, v53 row_shl:1 row_mask:0xf bank_mask:0xf
    v_mfma_f32_16x16x32_bf16 a[20:23], v[64:67], v[148:151], a[20:23]
    v_mov_b32_dpp v54, v54 row_shl:1 row_mask:0xf bank_mask:0xf
    v_mfma_f32_16x16x32_bf16 a[16:19], v[68:71], v[152:155], a[16:19]
    v_mov_b32_dpp v55, v55 row_shl:1 row_mask:0xf bank_mask:0xf
    v_mfma_f32_16x16x32_bf16 a[20:23], v[68:71], v[156:159], a[20:23]
    s_mov_b64 exec, s[46:47]
    buffer_load_dwordx4 v[48:51], v1, s[12:15], s35 offen offset:0
    buffer_load_dwordx4 v[52:55], v1, s[12:15], s35 offen offset:64
    s_mov_b64 exec, -1
    v_mfma_f32_16x16x32_bf16 a[24:27], v[72:75], v[144:147], a[24:27]
    v_mfma_f32_16x16x32_bf16 a[28:31], v[72:75], v[148:151], a[28:31]
    s_add_u32 s37, s36, 131072
    s_add_u32 m0, s28, 0
    v_mfma_f32_16x16x32_bf16 a[24:27], v[76:79], v[152:155], a[24:27]
    buffer_load_dwordx4 v2, s[16:19], s37 offen offset:0 lds
    v_mfma_f32_16x16x32_bf16 a[28:31], v[76:79], v[156:159], a[28:31]
    buffer_load_dwordx4 v3, s[16:19], s37 offen offset:1024 lds
    v_mfma_f32_16x16x32_bf16 a[32:35], v[16:19], v[144:147], a[32:35]
    buffer_load_dwordx4 v4, s[16:19], s37 offen offset:2048 lds
    v_mfma_f32_16x16x32_bf16 a[36:39], v[16:19], v[148:151], a[36:39]
    buffer_load_dwordx4 v5, s[16:19], s37 offen offset:3072 lds
    v_mfma_f32_16x16x32_bf16 a[32:35], v[20:23], v[152:155], a[32:35]
    ds_read_b64_tr_b16 v[160:161], v6 offset:4096
    v_mfma_f32_16x16x32_bf16 a[36:39], v[20:23], v[156:159], a[36:39]
    ds_read_b64_tr_b16 v[162:163], v6 offset:4352
    v_mfma_f32_16x16x32_bf16 a[40:43], v[24:27], v[144:147], a[40:43]
    ds_read_b64_tr_b16 v[164:165], v7 offset:4096
    v_mfma_f32_16x16x32_bf16 a[44:47], v[24:27], v[148:151], a[44:47]
    ds_read_b64_tr_b16 v[166:167], v7 offset:4352
    v_mfma_f32_16x16x32_bf16 a[40:43], v[28:31], v[152:155], a[40:43]
    ds_read_b64_tr_b16 v[168:169], v6 offset:6144
    v_mfma_f32_16x16x32_bf16 a[44:47], v[28:31], v[156:159], a[44:47]
    ds_read_b64_tr_b16 v[170:171], v6 offset:6400
    v_mfma_f32_16x16x32_bf16 a[48:51], v[32:35], v[144:147], a[48:51]
    ds_read_b64_tr_b16 v[172:173], v7 offset:6144
    ds_read_b128 v[112:115], v10 offset:8192
    ds_read_b128 v[116:119], v11 offset:8192
    v_mfma_f32_16x16x32_bf16 a[52:55], v[32:35], v[148:151], a[52:55]
    ds_read_b64_tr_b16 v[174:175], v7 offset:6400
    v_mfma_f32_16x16x32_bf16 a[48:51], v[36:39], v[152:155], a[48:51]
    v_mfma_f32_16x16x32_bf16 a[52:55], v[36:39], v[156:159], a[52:55]
    s_waitcnt vmcnt(12)
    v_mfma_f32_16x16x32_bf16 a[56:59], v[40:43], v[144:147], a[56:59]
    v_mfma_f32_16x16x32_bf16 a[60:63], v[40:43], v[148:151], a[60:63]
    v_mfma_f32_16x16x32_bf16 a[56:59], v[44:47], v[152:155], a[56:59]
    v_mfma_f32_16x16x32_bf16 a[60:63], v[44:47], v[156:159], a[60:63]
    s_waitcnt lgkmcnt(0)
    v_mfma_f32_16x16x32_bf16 a[0:3], v[56:59], v[160:163], a[0:3]
    v_mfma_f32_16x16x32_bf16 a[4:7], v[56:59], v[164:167], a[4:7]
    v_mfma_f32_16x16x32_bf16 a[0:3], v[60:63], v[168:171], a[0:3]
    v_mfma_f32_16x16x32_bf16 a[4:7], v[60:63], v[172:175], a[4:7]
    v_mov_b32_dpp v56, v56 row_shl:1 row_mask:0xf bank_mask:0xf
    v_mfma_f32_16x16x32_bf16 a[8:11], v[64:67], v[160:163], a[8:11]
    v_mov_b32_dpp v57, v57 row_shl:1 row_mask:0xf bank_mask:0xf
    v_mfma_f32_16x16x32_bf16 a[12:15], v[64:67], v[164:167], a[12:15]
    v_mov_b32_dpp v58, v58 row_shl:1 row_mask:0xf bank_mask:0xf
    v_mfma_f32_16x16x32_bf16 a[8:11], v[68:71], v[168:171], a[8:11]
    v_mov_b32_dpp v59, v59 row_shl:1 row_mask:0xf bank_mask:0xf
    v_mfma_f32_16x16x32_bf16 a[12:15], v[68:71], v[172:175], a[12:15]
    v_mov_b32_dpp v60, v60 row_shl:1 row_mask:0xf bank_mask:0xf
    v_mfma_f32_16x16x32_bf16 a[16:19], v[72:75], v[160:163], a[16:19]
    v_mov_b32_dpp v61, v61 row_shl:1 row_mask:0xf bank_mask:0xf
    v_mfma_f32_16x16x32_bf16 a[20:23], v[72:75], v[164:167], a[20:23]
    v_mov_b32_dpp v62, v62 row_shl:1 row_mask:0xf bank_mask:0xf
    v_mfma_f32_16x16x32_bf16 a[16:19], v[76:79], v[168:171], a[16:19]
    v_mov_b32_dpp v63, v63 row_shl:1 row_mask:0xf bank_mask:0xf
    v_mfma_f32_16x16x32_bf16 a[20:23], v[76:79], v[172:175], a[20:23]
    s_mov_b64 exec, s[46:47]
    buffer_load_dwordx4 v[56:59], v1, s[12:15], s35 offen offset:1024
    buffer_load_dwordx4 v[60:63], v1, s[12:15], s35 offen offset:1088
    s_mov_b64 exec, -1
    v_mfma_f32_16x16x32_bf16 a[24:27], v[16:19], v[160:163], a[24:27]
    v_mfma_f32_16x16x32_bf16 a[28:31], v[16:19], v[164:167], a[28:31]
    s_add_u32 s37, s36, 393216
    s_add_u32 m0, s28, 4096
    v_mfma_f32_16x16x32_bf16 a[24:27], v[20:23], v[168:171], a[24:27]
    buffer_load_dwordx4 v2, s[16:19], s37 offen offset:0 lds
    v_mfma_f32_16x16x32_bf16 a[28:31], v[20:23], v[172:175], a[28:31]
    buffer_load_dwordx4 v3, s[16:19], s37 offen offset:1024 lds
    v_mfma_f32_16x16x32_bf16 a[32:35], v[24:27], v[160:163], a[32:35]
    buffer_load_dwordx4 v4, s[16:19], s37 offen offset:2048 lds
    v_mfma_f32_16x16x32_bf16 a[36:39], v[24:27], v[164:167], a[36:39]
    buffer_load_dwordx4 v5, s[16:19], s37 offen offset:3072 lds
    v_mfma_f32_16x16x32_bf16 a[32:35], v[28:31], v[168:171], a[32:35]
    ds_read_b64_tr_b16 v[144:145], v6 offset:8192
    v_mfma_f32_16x16x32_bf16 a[36:39], v[28:31], v[172:175], a[36:39]
    ds_read_b64_tr_b16 v[146:147], v6 offset:8448
    v_mfma_f32_16x16x32_bf16 a[40:43], v[32:35], v[160:163], a[40:43]
    ds_read_b64_tr_b16 v[148:149], v7 offset:8192
    v_mfma_f32_16x16x32_bf16 a[44:47], v[32:35], v[164:167], a[44:47]
    ds_read_b64_tr_b16 v[150:151], v7 offset:8448
    v_mfma_f32_16x16x32_bf16 a[40:43], v[36:39], v[168:171], a[40:43]
    ds_read_b64_tr_b16 v[152:153], v6 offset:10240
    v_mfma_f32_16x16x32_bf16 a[44:47], v[36:39], v[172:175], a[44:47]
    ds_read_b64_tr_b16 v[154:155], v6 offset:10496
    v_mfma_f32_16x16x32_bf16 a[48:51], v[40:43], v[160:163], a[48:51]
    ds_read_b64_tr_b16 v[156:157], v7 offset:10240
    ds_read_b128 v[120:123], v10 offset:10240
    ds_read_b128 v[124:127], v11 offset:10240
    v_mfma_f32_16x16x32_bf16 a[52:55], v[40:43], v[164:167], a[52:55]
    ds_read_b64_tr_b16 v[158:159], v7 offset:10496
    v_mfma_f32_16x16x32_bf16 a[48:51], v[44:47], v[168:171], a[48:51]
    v_mfma_f32_16x16x32_bf16 a[52:55], v[44:47], v[172:175], a[52:55]
    s_waitcnt vmcnt(10)
    v_mfma_f32_16x16x32_bf16 a[56:59], v[48:51], v[160:163], a[56:59]
    v_mfma_f32_16x16x32_bf16 a[60:63], v[48:51], v[164:167], a[60:63]
    v_mfma_f32_16x16x32_bf16 a[56:59], v[52:55], v[168:171], a[56:59]
    v_mfma_f32_16x16x32_bf16 a[60:63], v[52:55], v[172:175], a[60:63]
    s_waitcnt lgkmcnt(0)
    v_mfma_f32_16x16x32_bf16 a[0:3], v[64:67], v[144:147], a[0:3]
    v_mfma_f32_16x16x32_bf16 a[4:7], v[64:67], v[148:151], a[4:7]
    v_mfma_f32_16x16x32_bf16 a[0:3], v[68:71], v[152:155], a[0:3]
    v_mfma_f32_16x16x32_bf16 a[4:7], v[68:71], v[156:159], a[4:7]
    v_mov_b32_dpp v64, v64 row_shl:1 row_mask:0xf bank_mask:0xf
    v_mfma_f32_16x16x32_bf16 a[8:11], v[72:75], v[144:147], a[8:11]
    v_mov_b32_dpp v65, v65 row_shl:1 row_mask:0xf bank_mask:0xf
    v_mfma_f32_16x16x32_bf16 a[12:15], v[72:75], v[148:151], a[12:15]
    v_mov_b32_dpp v66, v66 row_shl:1 row_mask:0xf bank_mask:0xf
    v_mfma_f32_16x16x32_bf16 a[8:11], v[76:79], v[152:155], a[8:11]
    v_mov_b32_dpp v67, v67 row_shl:1 row_mask:0xf bank_mask:0xf
    v_mfma_f32_16x16x32_bf16 a[12:15], v[76:79], v[156:159], a[12:15]
    v_mov_b32_dpp v68, v68 row_shl:1 row_mask:0xf bank_mask:0xf
    v_mfma_f32_16x16x32_bf16 a[16:19], v[16:19], v[144:147], a[16:19]
    v_mov_b32_dpp v69, v69 row_shl:1 row_mask:0xf bank_mask:0xf
    v_mfma_f32_16x16x32_bf16 a[20:23], v[16:19], v[148:151], a[20:23]
    v_mov_b32_dpp v70, v70 row_shl:1 row_mask:0xf bank_mask:0xf
    v_mfma_f32_16x16x32_bf16 a[16:19], v[20:23], v[152:155], a[16:19]
    v_mov_b32_dpp v71, v71 row_shl:1 row_mask:0xf bank_mask:0xf
    v_mfma_f32_16x16x32_bf16 a[20:23], v[20:23], v[156:159], a[20:23]
    s_mov_b64 exec, s[46:47]
    buffer_load_dwordx4 v[64:67], v1, s[12:15], s35 offen offset:2048
    buffer_load_dwordx4 v[68:71], v1, s[12:15], s35 offen offset:2112
    s_mov_b64 exec, -1
    v_mfma_f32_16x16x32_bf16 a[24:27], v[24:27], v[144:147], a[24:27]
    v_mfma_f32_16x16x32_bf16 a[28:31], v[24:27], v[148:151], a[28:31]
    s_add_u32 s37, s36, 655360
    s_add_u32 m0, s28, 8192
    v_mfma_f32_16x16x32_bf16 a[24:27], v[28:31], v[152:155], a[24:27]
    buffer_load_dwordx4 v2, s[16:19], s37 offen offset:0 lds
    v_mfma_f32_16x16x32_bf16 a[28:31], v[28:31], v[156:159], a[28:31]
    buffer_load_dwordx4 v3, s[16:19], s37 offen offset:1024 lds
    v_mfma_f32_16x16x32_bf16 a[32:35], v[32:35], v[144:147], a[32:35]
    buffer_load_dwordx4 v4, s[16:19], s37 offen offset:2048 lds
    v_mfma_f32_16x16x32_bf16 a[36:39], v[32:35], v[148:151], a[36:39]
    buffer_load_dwordx4 v5, s[16:19], s37 offen offset:3072 lds
    v_mfma_f32_16x16x32_bf16 a[32:35], v[36:39], v[152:155], a[32:35]
    ds_read_b64_tr_b16 v[160:161], v6 offset:12288
    v_mfma_f32_16x16x32_bf16 a[36:39], v[36:39], v[156:159], a[36:39]
    ds_read_b64_tr_b16 v[162:163], v6 offset:12544
    v_mfma_f32_16x16x32_bf16 a[40:43], v[40:43], v[144:147], a[40:43]
    ds_read_b64_tr_b16 v[164:165], v7 offset:12288
    v_mfma_f32_16x16x32_bf16 a[44:47], v[40:43], v[148:151], a[44:47]
    ds_read_b64_tr_b16 v[166:167], v7 offset:12544
    v_mfma_f32_16x16x32_bf16 a[40:43], v[44:47], v[152:155], a[40:43]
    ds_read_b64_tr_b16 v[168:169], v6 offset:14336
    v_mfma_f32_16x16x32_bf16 a[44:47], v[44:47], v[156:159], a[44:47]
    ds_read_b64_tr_b16 v[170:171], v6 offset:14592
    v_mfma_f32_16x16x32_bf16 a[48:51], v[48:51], v[144:147], a[48:51]
    ds_read_b64_tr_b16 v[172:173], v7 offset:14336
    ds_read_b128 v[128:131], v10 offset:12288
    ds_read_b128 v[132:135], v11 offset:12288
    v_mfma_f32_16x16x32_bf16 a[52:55], v[48:51], v[148:151], a[52:55]
    ds_read_b64_tr_b16 v[174:175], v7 offset:14592
    v_mfma_f32_16x16x32_bf16 a[48:51], v[52:55], v[152:155], a[48:51]
    v_mfma_f32_16x16x32_bf16 a[52:55], v[52:55], v[156:159], a[52:55]
    s_waitcnt vmcnt(10)
    v_mfma_f32_16x16x32_bf16 a[56:59], v[56:59], v[144:147], a[56:59]
    v_mfma_f32_16x16x32_bf16 a[60:63], v[56:59], v[148:151], a[60:63]
    v_mfma_f32_16x16x32_bf16 a[56:59], v[60:63], v[152:155], a[56:59]
    v_mfma_f32_16x16x32_bf16 a[60:63], v[60:63], v[156:159], a[60:63]
    s_waitcnt lgkmcnt(0)
    v_mfma_f32_16x16x32_bf16 a[0:3], v[72:75], v[160:163], a[0:3]
    v_mfma_f32_16x16x32_bf16 a[4:7], v[72:75], v[164:167], a[4:7]
    v_mfma_f32_16x16x32_bf16 a[0:3], v[76:79], v[168:171], a[0:3]
    v_mfma_f32_16x16x32_bf16 a[4:7], v[76:79], v[172:175], a[4:7]
    v_mfma_f32_16x16x32_bf16 a[8:11], v[16:19], v[160:163], a[8:11]
    v_mfma_f32_16x16x32_bf16 a[12:15], v[16:19], v[164:167], a[12:15]
    v_mfma_f32_16x16x32_bf16 a[8:11], v[20:23], v[168:171], a[8:11]
    v_mfma_f32_16x16x32_bf16 a[12:15], v[20:23], v[172:175], a[12:15]
    v_mfma_f32_16x16x32_bf16 a[16:19], v[24:27], v[160:163], a[16:19]
    v_mfma_f32_16x16x32_bf16 a[20:23], v[24:27], v[164:167], a[20:23]
    v_mfma_f32_16x16x32_bf16 a[16:19], v[28:31], v[168:171], a[16:19]
    v_mfma_f32_16x16x32_bf16 a[20:23], v[28:31], v[172:175], a[20:23]
    v_mfma_f32_16x16x32_bf16 a[24:27], v[32:35], v[160:163], a[24:27]
    v_mfma_f32_16x16x32_bf16 a[28:31], v[32:35], v[164:167], a[28:31]
    s_add_u32 s37, s36, 917504
    s_add_u32 m0, s28, 12288
    v_mfma_f32_16x16x32_bf16 a[24:27], v[36:39], v[168:171], a[24:27]
    buffer_load_dwordx4 v2, s[16:19], s37 offen offset:0 lds
    v_mfma_f32_16x16x32_bf16 a[28:31], v[36:39], v[172:175], a[28:31]
    buffer_load_dwordx4 v3, s[16:19], s37 offen offset:1024 lds
    v_mfma_f32_16x16x32_bf16 a[32:35], v[40:43], v[160:163], a[32:35]
    buffer_load_dwordx4 v4, s[16:19], s37 offen offset:2048 lds
    v_mfma_f32_16x16x32_bf16 a[36:39], v[40:43], v[164:167], a[36:39]
    buffer_load_dwordx4 v5, s[16:19], s37 offen offset:3072 lds
    v_mfma_f32_16x16x32_bf16 a[32:35], v[44:47], v[168:171], a[32:35]
    ds_read_b64_tr_b16 v[144:145], v6 offset:0
    v_mfma_f32_16x16x32_bf16 a[36:39], v[44:47], v[172:175], a[36:39]
    ds_read_b64_tr_b16 v[146:147], v6 offset:256
    v_mfma_f32_16x16x32_bf16 a[40:43], v[48:51], v[160:163], a[40:43]
    ds_read_b64_tr_b16 v[148:149], v7 offset:0
    v_mfma_f32_16x16x32_bf16 a[44:47], v[48:51], v[164:167], a[44:47]
    ds_read_b64_tr_b16 v[150:151], v7 offset:256
    v_mfma_f32_16x16x32_bf16 a[40:43], v[52:55], v[168:171], a[40:43]
    ds_read_b64_tr_b16 v[152:153], v6 offset:2048
    v_mfma_f32_16x16x32_bf16 a[44:47], v[52:55], v[172:175], a[44:47]
    ds_read_b64_tr_b16 v[154:155], v6 offset:2304
    v_mfma_f32_16x16x32_bf16 a[48:51], v[56:59], v[160:163], a[48:51]
    ds_read_b64_tr_b16 v[156:157], v7 offset:2048
    ds_read_b128 v[136:139], v10 offset:14336
    ds_read_b128 v[140:143], v11 offset:14336
    v_mfma_f32_16x16x32_bf16 a[52:55], v[56:59], v[164:167], a[52:55]
    ds_read_b64_tr_b16 v[158:159], v7 offset:2304
    v_mfma_f32_16x16x32_bf16 a[48:51], v[60:63], v[168:171], a[48:51]
    v_mfma_f32_16x16x32_bf16 a[52:55], v[60:63], v[172:175], a[52:55]
    s_waitcnt vmcnt(8)
    v_mfma_f32_16x16x32_bf16 a[56:59], v[64:67], v[160:163], a[56:59]
    v_mfma_f32_16x16x32_bf16 a[60:63], v[64:67], v[164:167], a[60:63]
    v_mfma_f32_16x16x32_bf16 a[56:59], v[68:71], v[168:171], a[56:59]
    v_mfma_f32_16x16x32_bf16 a[60:63], v[68:71], v[172:175], a[60:63]
    s_waitcnt lgkmcnt(0)
    v_mfma_f32_16x16x32_bf16 a[0:3], v[80:83], v[144:147], a[0:3]
    v_mfma_f32_16x16x32_bf16 a[4:7], v[80:83], v[148:151], a[4:7]
    v_mfma_f32_16x16x32_bf16 a[0:3], v[84:87], v[152:155], a[0:3]
    v_mfma_f32_16x16x32_bf16 a[4:7], v[84:87], v[156:159], a[4:7]
    v_mov_b32_dpp v80, v80 row_shl:1 row_mask:0xf bank_mask:0xf
    v_mfma_f32_16x16x32_bf16 a[8:11], v[88:91], v[144:147], a[8:11]
    v_mov_b32_dpp v81, v81 row_shl:1 row_mask:0xf bank_mask:0xf
    v_mfma_f32_16x16x32_bf16 a[12:15], v[88:91], v[148:151], a[12:15]
    v_mov_b32_dpp v82, v82 row_shl:1 row_mask:0xf bank_mask:0xf
    v_mfma_f32_16x16x32_bf16 a[8:11], v[92:95], v[152:155], a[8:11]
    v_mov_b32_dpp v83, v83 row_shl:1 row_mask:0xf bank_mask:0xf
    v_mfma_f32_16x16x32_bf16 a[12:15], v[92:95], v[156:159], a[12:15]
    v_mov_b32_dpp v84, v84 row_shl:1 row_mask:0xf bank_mask:0xf
    v_mfma_f32_16x16x32_bf16 a[16:19], v[96:99], v[144:147], a[16:19]
    v_mov_b32_dpp v85, v85 row_shl:1 row_mask:0xf bank_mask:0xf
    v_mfma_f32_16x16x32_bf16 a[20:23], v[96:99], v[148:151], a[20:23]
    v_mov_b32_dpp v86, v86 row_shl:1 row_mask:0xf bank_mask:0xf
    v_mfma_f32_16x16x32_bf16 a[16:19], v[100:103], v[152:155], a[16:19]
    v_mov_b32_dpp v87, v87 row_shl:1 row_mask:0xf bank_mask:0xf
    v_mfma_f32_16x16x32_bf16 a[20:23], v[100:103], v[156:159], a[20:23]
    s_mov_b64 exec, s[46:47]
    buffer_load_dwordx4 v[80:83], v1, s[12:15], s32 offen offset:512
    buffer_load_dwordx4 v[84:87], v1, s[12:15], s32 offen offset:576
    s_mov_b64 exec, -1
    v_mfma_f32_16x16x32_bf16 a[24:27], v[104:107], v[144:147], a[24:27]
    v_mfma_f32_16x16x32_bf16 a[28:31], v[104:107], v[148:151], a[28:31]
    s_add_u32 s37, s36, 1179648
    s_add_u32 m0, s28, 0
    v_mfma_f32_16x16x32_bf16 a[24:27], v[108:111], v[152:155], a[24:27]
    buffer_load_dwordx4 v2, s[16:19], s37 offen offset:0 lds
    v_mfma_f32_16x16x32_bf16 a[28:31], v[108:111], v[156:159], a[28:31]
    buffer_load_dwordx4 v3, s[16:19], s37 offen offset:1024 lds
    v_mfma_f32_16x16x32_bf16 a[32:35], v[112:115], v[144:147], a[32:35]
    buffer_load_dwordx4 v4, s[16:19], s37 offen offset:2048 lds
    v_mfma_f32_16x16x32_bf16 a[36:39], v[112:115], v[148:151], a[36:39]
    buffer_load_dwordx4 v5, s[16:19], s37 offen offset:3072 lds
    v_mfma_f32_16x16x32_bf16 a[32:35], v[116:119], v[152:155], a[32:35]
    ds_read_b64_tr_b16 v[160:161], v6 offset:4096
    v_mfma_f32_16x16x32_bf16 a[36:39], v[116:119], v[156:159], a[36:39]
    ds_read_b64_tr_b16 v[162:163], v6 offset:4352
    v_mfma_f32_16x16x32_bf16 a[40:43], v[120:123], v[144:147], a[40:43]
    ds_read_b64_tr_b16 v[164:165], v7 offset:4096
    v_mfma_f32_16x16x32_bf16 a[44:47], v[120:123], v[148:151], a[44:47]
    ds_read_b64_tr_b16 v[166:167], v7 offset:4352
    v_mfma_f32_16x16x32_bf16 a[40:43], v[124:127], v[152:155], a[40:43]
    ds_read_b64_tr_b16 v[168:169], v6 offset:6144
    v_mfma_f32_16x16x32_bf16 a[44:47], v[124:127], v[156:159], a[44:47]
    ds_read_b64_tr_b16 v[170:171], v6 offset:6400
    v_mfma_f32_16x16x32_bf16 a[48:51], v[128:131], v[144:147], a[48:51]
    ds_read_b64_tr_b16 v[172:173], v7 offset:6144
    v_mfma_f32_16x16x32_bf16 a[52:55], v[128:131], v[148:151], a[52:55]
    ds_read_b64_tr_b16 v[174:175], v7 offset:6400
    v_mfma_f32_16x16x32_bf16 a[48:51], v[132:135], v[152:155], a[48:51]
    v_mfma_f32_16x16x32_bf16 a[52:55], v[132:135], v[156:159], a[52:55]
    v_mfma_f32_16x16x32_bf16 a[56:59], v[136:139], v[144:147], a[56:59]
    v_mfma_f32_16x16x32_bf16 a[60:63], v[136:139], v[148:151], a[60:63]
    v_mfma_f32_16x16x32_bf16 a[56:59], v[140:143], v[152:155], a[56:59]
    v_mfma_f32_16x16x32_bf16 a[60:63], v[140:143], v[156:159], a[60:63]
    s_waitcnt lgkmcnt(0)
    v_mfma_f32_16x16x32_bf16 a[0:3], v[88:91], v[160:163], a[0:3]
    v_mfma_f32_16x16x32_bf16 a[4:7], v[88:91], v[164:167], a[4:7]
    v_mfma_f32_16x16x32_bf16 a[0:3], v[92:95], v[168:171], a[0:3]
    v_mfma_f32_16x16x32_bf16 a[4:7], v[92:95], v[172:175], a[4:7]
    v_mov_b32_dpp v88, v88 row_shl:1 row_mask:0xf bank_mask:0xf
    v_mfma_f32_16x16x32_bf16 a[8:11], v[96:99], v[160:163], a[8:11]
    v_mov_b32_dpp v89, v89 row_shl:1 row_mask:0xf bank_mask:0xf
    v_mfma_f32_16x16x32_bf16 a[12:15], v[96:99], v[164:167], a[12:15]
    v_mov_b32_dpp v90, v90 row_shl:1 row_mask:0xf bank_mask:0xf
    v_mfma_f32_16x16x32_bf16 a[8:11], v[100:103], v[168:171], a[8:11]
    v_mov_b32_dpp v91, v91 row_shl:1 row_mask:0xf bank_mask:0xf
    v_mfma_f32_16x16x32_bf16 a[12:15], v[100:103], v[172:175], a[12:15]
    v_mov_b32_dpp v92, v92 row_shl:1 row_mask:0xf bank_mask:0xf
    v_mfma_f32_16x16x32_bf16 a[16:19], v[104:107], v[160:163], a[16:19]
    v_mov_b32_dpp v93, v93 row_shl:1 row_mask:0xf bank_mask:0xf
    v_mfma_f32_16x16x32_bf16 a[20:23], v[104:107], v[164:167], a[20:23]
    v_mov_b32_dpp v94, v94 row_shl:1 row_mask:0xf bank_mask:0xf
    v_mfma_f32_16x16x32_bf16 a[16:19], v[108:111], v[168:171], a[16:19]
    v_mov_b32_dpp v95, v95 row_shl:1 row_mask:0xf bank_mask:0xf
    v_mfma_f32_16x16x32_bf16 a[20:23], v[108:111], v[172:175], a[20:23]
    s_mov_b64 exec, s[46:47]
    buffer_load_dwordx4 v[88:91], v1, s[12:15], s32 offen offset:1536
    buffer_load_dwordx4 v[92:95], v1, s[12:15], s32 offen offset:1600
    s_mov_b64 exec, -1
    v_mfma_f32_16x16x32_bf16 a[24:27], v[112:115], v[160:163], a[24:27]
    v_mfma_f32_16x16x32_bf16 a[28:31], v[112:115], v[164:167], a[28:31]
    s_add_u32 s37, s36, 1441792
    s_add_u32 m0, s28, 4096
    v_mfma_f32_16x16x32_bf16 a[24:27], v[116:119], v[168:171], a[24:27]
    buffer_load_dwordx4 v2, s[16:19], s37 offen offset:0 lds
    v_mfma_f32_16x16x32_bf16 a[28:31], v[116:119], v[172:175], a[28:31]
    buffer_load_dwordx4 v3, s[16:19], s37 offen offset:1024 lds
    v_mfma_f32_16x16x32_bf16 a[32:35], v[120:123], v[160:163], a[32:35]
    buffer_load_dwordx4 v4, s[16:19], s37 offen offset:2048 lds
    v_mfma_f32_16x16x32_bf16 a[36:39], v[120:123], v[164:167], a[36:39]
    buffer_load_dwordx4 v5, s[16:19], s37 offen offset:3072 lds
    v_mfma_f32_16x16x32_bf16 a[32:35], v[124:127], v[168:171], a[32:35]
    s_waitcnt vmcnt(16)
    ds_read_b64_tr_b16 v[144:145], v6 offset:8192
    v_mfma_f32_16x16x32_bf16 a[36:39], v[124:127], v[172:175], a[36:39]
    ds_read_b64_tr_b16 v[146:147], v6 offset:8448
    v_mfma_f32_16x16x32_bf16 a[40:43], v[128:131], v[160:163], a[40:43]
    ds_read_b64_tr_b16 v[148:149], v7 offset:8192
    v_mfma_f32_16x16x32_bf16 a[44:47], v[128:131], v[164:167], a[44:47]
    ds_read_b64_tr_b16 v[150:151], v7 offset:8448
    v_mfma_f32_16x16x32_bf16 a[40:43], v[132:135], v[168:171], a[40:43]
    ds_read_b64_tr_b16 v[152:153], v6 offset:10240
    v_mfma_f32_16x16x32_bf16 a[44:47], v[132:135], v[172:175], a[44:47]
    ds_read_b64_tr_b16 v[154:155], v6 offset:10496
    v_mfma_f32_16x16x32_bf16 a[48:51], v[136:139], v[160:163], a[48:51]
    ds_read_b64_tr_b16 v[156:157], v7 offset:10240
    v_mfma_f32_16x16x32_bf16 a[52:55], v[136:139], v[164:167], a[52:55]
    ds_read_b64_tr_b16 v[158:159], v7 offset:10496
    v_mfma_f32_16x16x32_bf16 a[48:51], v[140:143], v[168:171], a[48:51]
    v_mfma_f32_16x16x32_bf16 a[52:55], v[140:143], v[172:175], a[52:55]
    s_waitcnt vmcnt(10)
    v_mfma_f32_16x16x32_bf16 a[56:59], v[80:83], v[160:163], a[56:59]
    v_mfma_f32_16x16x32_bf16 a[60:63], v[80:83], v[164:167], a[60:63]
    v_mfma_f32_16x16x32_bf16 a[56:59], v[84:87], v[168:171], a[56:59]
    v_mfma_f32_16x16x32_bf16 a[60:63], v[84:87], v[172:175], a[60:63]
    s_waitcnt lgkmcnt(0)
    v_mfma_f32_16x16x32_bf16 a[0:3], v[96:99], v[144:147], a[0:3]
    v_mfma_f32_16x16x32_bf16 a[4:7], v[96:99], v[148:151], a[4:7]
    v_mfma_f32_16x16x32_bf16 a[0:3], v[100:103], v[152:155], a[0:3]
    v_mfma_f32_16x16x32_bf16 a[4:7], v[100:103], v[156:159], a[4:7]
    v_mov_b32_dpp v96, v96 row_shl:1 row_mask:0xf bank_mask:0xf
    v_mfma_f32_16x16x32_bf16 a[8:11], v[104:107], v[144:147], a[8:11]
    v_mov_b32_dpp v97, v97 row_shl:1 row_mask:0xf bank_mask:0xf
    v_mfma_f32_16x16x32_bf16 a[12:15], v[104:107], v[148:151], a[12:15]
    v_mov_b32_dpp v98, v98 row_shl:1 row_mask:0xf bank_mask:0xf
    v_mfma_f32_16x16x32_bf16 a[8:11], v[108:111], v[152:155], a[8:11]
    v_mov_b32_dpp v99, v99 row_shl:1 row_mask:0xf bank_mask:0xf
    v_mfma_f32_16x16x32_bf16 a[12:15], v[108:111], v[156:159], a[12:15]
    v_mov_b32_dpp v100, v100 row_shl:1 row_mask:0xf bank_mask:0xf
    v_mfma_f32_16x16x32_bf16 a[16:19], v[112:115], v[144:147], a[16:19]
    v_mov_b32_dpp v101, v101 row_shl:1 row_mask:0xf bank_mask:0xf
    v_mfma_f32_16x16x32_bf16 a[20:23], v[112:115], v[148:151], a[20:23]
    v_mov_b32_dpp v102, v102 row_shl:1 row_mask:0xf bank_mask:0xf
    v_mfma_f32_16x16x32_bf16 a[16:19], v[116:119], v[152:155], a[16:19]
    v_mov_b32_dpp v103, v103 row_shl:1 row_mask:0xf bank_mask:0xf
    v_mfma_f32_16x16x32_bf16 a[20:23], v[116:119], v[156:159], a[20:23]
    s_mov_b64 exec, s[46:47]
    buffer_load_dwordx4 v[96:99], v1, s[12:15], s32 offen offset:2560
    buffer_load_dwordx4 v[100:103], v1, s[12:15], s32 offen offset:2624
    s_mov_b64 exec, -1
    v_mfma_f32_16x16x32_bf16 a[24:27], v[120:123], v[144:147], a[24:27]
    v_mfma_f32_16x16x32_bf16 a[28:31], v[120:123], v[148:151], a[28:31]
    s_add_u32 s37, s36, 1703936
    s_add_u32 m0, s28, 8192
    v_mfma_f32_16x16x32_bf16 a[24:27], v[124:127], v[152:155], a[24:27]
    buffer_load_dwordx4 v2, s[16:19], s37 offen offset:0 lds
    v_mfma_f32_16x16x32_bf16 a[28:31], v[124:127], v[156:159], a[28:31]
    buffer_load_dwordx4 v3, s[16:19], s37 offen offset:1024 lds
    v_mfma_f32_16x16x32_bf16 a[32:35], v[128:131], v[144:147], a[32:35]
    buffer_load_dwordx4 v4, s[16:19], s37 offen offset:2048 lds
    v_mfma_f32_16x16x32_bf16 a[36:39], v[128:131], v[148:151], a[36:39]
    buffer_load_dwordx4 v5, s[16:19], s37 offen offset:3072 lds
    v_mfma_f32_16x16x32_bf16 a[32:35], v[132:135], v[152:155], a[32:35]
    ds_read_b64_tr_b16 v[160:161], v6 offset:12288
    v_mfma_f32_16x16x32_bf16 a[36:39], v[132:135], v[156:159], a[36:39]
    ds_read_b64_tr_b16 v[162:163], v6 offset:12544
    v_mfma_f32_16x16x32_bf16 a[40:43], v[136:139], v[144:147], a[40:43]
    ds_read_b64_tr_b16 v[164:165], v7 offset:12288
    v_mfma_f32_16x16x32_bf16 a[44:47], v[136:139], v[148:151], a[44:47]
    ds_read_b64_tr_b16 v[166:167], v7 offset:12544
    v_mfma_f32_16x16x32_bf16 a[40:43], v[140:143], v[152:155], a[40:43]
    ds_read_b64_tr_b16 v[168:169], v6 offset:14336
    v_mfma_f32_16x16x32_bf16 a[44:47], v[140:143], v[156:159], a[44:47]
    ds_read_b64_tr_b16 v[170:171], v6 offset:14592
    v_mfma_f32_16x16x32_bf16 a[48:51], v[80:83], v[144:147], a[48:51]
    ds_read_b64_tr_b16 v[172:173], v7 offset:14336
    v_mfma_f32_16x16x32_bf16 a[52:55], v[80:83], v[148:151], a[52:55]
    ds_read_b64_tr_b16 v[174:175], v7 offset:14592
    v_mfma_f32_16x16x32_bf16 a[48:51], v[84:87], v[152:155], a[48:51]
    v_mfma_f32_16x16x32_bf16 a[52:55], v[84:87], v[156:159], a[52:55]
    s_waitcnt vmcnt(10)
    v_mfma_f32_16x16x32_bf16 a[56:59], v[88:91], v[144:147], a[56:59]
    v_mfma_f32_16x16x32_bf16 a[60:63], v[88:91], v[148:151], a[60:63]
    v_mfma_f32_16x16x32_bf16 a[56:59], v[92:95], v[152:155], a[56:59]
    v_mfma_f32_16x16x32_bf16 a[60:63], v[92:95], v[156:159], a[60:63]
    s_waitcnt lgkmcnt(0)
    v_mfma_f32_16x16x32_bf16 a[0:3], v[104:107], v[160:163], a[0:3]
    v_mfma_f32_16x16x32_bf16 a[4:7], v[104:107], v[164:167], a[4:7]
    v_mfma_f32_16x16x32_bf16 a[0:3], v[108:111], v[168:171], a[0:3]
    v_mfma_f32_16x16x32_bf16 a[4:7], v[108:111], v[172:175], a[4:7]
    v_mov_b32_dpp v104, v104 row_shl:1 row_mask:0xf bank_mask:0xf
    v_mfma_f32_16x16x32_bf16 a[8:11], v[112:115], v[160:163], a[8:11]
    v_mov_b32_dpp v105, v105 row_shl:1 row_mask:0xf bank_mask:0xf
    v_mfma_f32_16x16x32_bf16 a[12:15], v[112:115], v[164:167], a[12:15]
    v_mov_b32_dpp v106, v106 row_shl:1 row_mask:0xf bank_mask:0xf
    v_mfma_f32_16x16x32_bf16 a[8:11], v[116:119], v[168:171], a[8:11]
    v_mov_b32_dpp v107, v107 row_shl:1 row_mask:0xf bank_mask:0xf
    v_mfma_f32_16x16x32_bf16 a[12:15], v[116:119], v[172:175], a[12:15]
    v_mov_b32_dpp v108, v108 row_shl:1 row_mask:0xf bank_mask:0xf
    v_mfma_f32_16x16x32_bf16 a[16:19], v[120:123], v[160:163], a[16:19]
    v_mov_b32_dpp v109, v109 row_shl:1 row_mask:0xf bank_mask:0xf
    v_mfma_f32_16x16x32_bf16 a[20:23], v[120:123], v[164:167], a[20:23]
    v_mov_b32_dpp v110, v110 row_shl:1 row_mask:0xf bank_mask:0xf
    v_mfma_f32_16x16x32_bf16 a[16:19], v[124:127], v[168:171], a[16:19]
    v_mov_b32_dpp v111, v111 row_shl:1 row_mask:0xf bank_mask:0xf
    v_mfma_f32_16x16x32_bf16 a[20:23], v[124:127], v[172:175], a[20:23]
    s_mov_b64 exec, s[46:47]
    buffer_load_dwordx4 v[104:107], v1, s[12:15], s32 offen offset:3584
    buffer_load_dwordx4 v[108:111], v1, s[12:15], s32 offen offset:3648
    s_mov_b64 exec, -1
    v_mfma_f32_16x16x32_bf16 a[24:27], v[128:131], v[160:163], a[24:27]
    v_mfma_f32_16x16x32_bf16 a[28:31], v[128:131], v[164:167], a[28:31]
    s_add_u32 s37, s36, 1966080
    s_add_u32 m0, s28, 12288
    v_mfma_f32_16x16x32_bf16 a[24:27], v[132:135], v[168:171], a[24:27]
    buffer_load_dwordx4 v2, s[16:19], s37 offen offset:0 lds
    v_mfma_f32_16x16x32_bf16 a[28:31], v[132:135], v[172:175], a[28:31]
    buffer_load_dwordx4 v3, s[16:19], s37 offen offset:1024 lds
    v_mfma_f32_16x16x32_bf16 a[32:35], v[136:139], v[160:163], a[32:35]
    buffer_load_dwordx4 v4, s[16:19], s37 offen offset:2048 lds
    v_mfma_f32_16x16x32_bf16 a[36:39], v[136:139], v[164:167], a[36:39]
    buffer_load_dwordx4 v5, s[16:19], s37 offen offset:3072 lds
    v_mfma_f32_16x16x32_bf16 a[32:35], v[140:143], v[168:171], a[32:35]
    ds_read_b64_tr_b16 v[144:145], v6 offset:0
    v_mfma_f32_16x16x32_bf16 a[36:39], v[140:143], v[172:175], a[36:39]
    ds_read_b64_tr_b16 v[146:147], v6 offset:256
    v_mfma_f32_16x16x32_bf16 a[40:43], v[80:83], v[160:163], a[40:43]
    ds_read_b64_tr_b16 v[148:149], v7 offset:0
    v_mfma_f32_16x16x32_bf16 a[44:47], v[80:83], v[164:167], a[44:47]
    ds_read_b64_tr_b16 v[150:151], v7 offset:256
    v_mfma_f32_16x16x32_bf16 a[40:43], v[84:87], v[168:171], a[40:43]
    ds_read_b64_tr_b16 v[152:153], v6 offset:2048
    v_mfma_f32_16x16x32_bf16 a[44:47], v[84:87], v[172:175], a[44:47]
    ds_read_b64_tr_b16 v[154:155], v6 offset:2304
    v_mfma_f32_16x16x32_bf16 a[48:51], v[88:91], v[160:163], a[48:51]
    ds_read_b64_tr_b16 v[156:157], v7 offset:2048
    v_mfma_f32_16x16x32_bf16 a[52:55], v[88:91], v[164:167], a[52:55]
    ds_read_b64_tr_b16 v[158:159], v7 offset:2304
    v_mfma_f32_16x16x32_bf16 a[48:51], v[92:95], v[168:171], a[48:51]
    v_mfma_f32_16x16x32_bf16 a[52:55], v[92:95], v[172:175], a[52:55]
    s_waitcnt vmcnt(10)
    v_mfma_f32_16x16x32_bf16 a[56:59], v[96:99], v[160:163], a[56:59]
    v_mfma_f32_16x16x32_bf16 a[60:63], v[96:99], v[164:167], a[60:63]
    v_mfma_f32_16x16x32_bf16 a[56:59], v[100:103], v[168:171], a[56:59]
    v_mfma_f32_16x16x32_bf16 a[60:63], v[100:103], v[172:175], a[60:63]
    s_waitcnt lgkmcnt(0)
    v_mfma_f32_16x16x32_bf16 a[0:3], v[112:115], v[144:147], a[0:3]
    v_mfma_f32_16x16x32_bf16 a[4:7], v[112:115], v[148:151], a[4:7]
    v_mfma_f32_16x16x32_bf16 a[0:3], v[116:119], v[152:155], a[0:3]
    v_mfma_f32_16x16x32_bf16 a[4:7], v[116:119], v[156:159], a[4:7]
    v_mov_b32_dpp v112, v112 row_shl:1 row_mask:0xf bank_mask:0xf
    v_mfma_f32_16x16x32_bf16 a[8:11], v[120:123], v[144:147], a[8:11]
    v_mov_b32_dpp v113, v113 row_shl:1 row_mask:0xf bank_mask:0xf
    v_mfma_f32_16x16x32_bf16 a[12:15], v[120:123], v[148:151], a[12:15]
    v_mov_b32_dpp v114, v114 row_shl:1 row_mask:0xf bank_mask:0xf
    v_mfma_f32_16x16x32_bf16 a[8:11], v[124:127], v[152:155], a[8:11]
    v_mov_b32_dpp v115, v115 row_shl:1 row_mask:0xf bank_mask:0xf
    v_mfma_f32_16x16x32_bf16 a[12:15], v[124:127], v[156:159], a[12:15]
    v_mov_b32_dpp v116, v116 row_shl:1 row_mask:0xf bank_mask:0xf
    v_mfma_f32_16x16x32_bf16 a[16:19], v[128:131], v[144:147], a[16:19]
    v_mov_b32_dpp v117, v117 row_shl:1 row_mask:0xf bank_mask:0xf
    v_mfma_f32_16x16x32_bf16 a[20:23], v[128:131], v[148:151], a[20:23]
    v_mov_b32_dpp v118, v118 row_shl:1 row_mask:0xf bank_mask:0xf
    v_mfma_f32_16x16x32_bf16 a[16:19], v[132:135], v[152:155], a[16:19]
    v_mov_b32_dpp v119, v119 row_shl:1 row_mask:0xf bank_mask:0xf
    v_mfma_f32_16x16x32_bf16 a[20:23], v[132:135], v[156:159], a[20:23]
    s_mov_b64 exec, s[46:47]
    buffer_load_dwordx4 v[112:115], v1, s[12:15], s33 offen offset:512
    buffer_load_dwordx4 v[116:119], v1, s[12:15], s33 offen offset:576
    s_mov_b64 exec, -1
    v_mfma_f32_16x16x32_bf16 a[24:27], v[136:139], v[144:147], a[24:27]
    v_mfma_f32_16x16x32_bf16 a[28:31], v[136:139], v[148:151], a[28:31]
    s_add_u32 s37, s36, 2228224
    s_add_u32 m0, s28, 0
    v_mfma_f32_16x16x32_bf16 a[24:27], v[140:143], v[152:155], a[24:27]
    buffer_load_dwordx4 v2, s[16:19], s37 offen offset:0 lds
    v_mfma_f32_16x16x32_bf16 a[28:31], v[140:143], v[156:159], a[28:31]
    buffer_load_dwordx4 v3, s[16:19], s37 offen offset:1024 lds
    v_mfma_f32_16x16x32_bf16 a[32:35], v[80:83], v[144:147], a[32:35]
    buffer_load_dwordx4 v4, s[16:19], s37 offen offset:2048 lds
    v_mfma_f32_16x16x32_bf16 a[36:39], v[80:83], v[148:151], a[36:39]
    buffer_load_dwordx4 v5, s[16:19], s37 offen offset:3072 lds
    v_mfma_f32_16x16x32_bf16 a[32:35], v[84:87], v[152:155], a[32:35]
    ds_read_b64_tr_b16 v[160:161], v6 offset:4096
    v_mfma_f32_16x16x32_bf16 a[36:39], v[84:87], v[156:159], a[36:39]
    ds_read_b64_tr_b16 v[162:163], v6 offset:4352
    v_mfma_f32_16x16x32_bf16 a[40:43], v[88:91], v[144:147], a[40:43]
    ds_read_b64_tr_b16 v[164:165], v7 offset:4096
    v_mfma_f32_16x16x32_bf16 a[44:47], v[88:91], v[148:151], a[44:47]
    ds_read_b64_tr_b16 v[166:167], v7 offset:4352
    v_mfma_f32_16x16x32_bf16 a[40:43], v[92:95], v[152:155], a[40:43]
    ds_read_b64_tr_b16 v[168:169], v6 offset:6144
    v_mfma_f32_16x16x32_bf16 a[44:47], v[92:95], v[156:159], a[44:47]
    ds_read_b64_tr_b16 v[170:171], v6 offset:6400
    v_mfma_f32_16x16x32_bf16 a[48:51], v[96:99], v[144:147], a[48:51]
    ds_read_b64_tr_b16 v[172:173], v7 offset:6144
    v_mfma_f32_16x16x32_bf16 a[52:55], v[96:99], v[148:151], a[52:55]
    ds_read_b64_tr_b16 v[174:175], v7 offset:6400
    v_mfma_f32_16x16x32_bf16 a[48:51], v[100:103], v[152:155], a[48:51]
    v_mfma_f32_16x16x32_bf16 a[52:55], v[100:103], v[156:159], a[52:55]
    s_waitcnt vmcnt(10)
    v_mfma_f32_16x16x32_bf16 a[56:59], v[104:107], v[144:147], a[56:59]
    v_mfma_f32_16x16x32_bf16 a[60:63], v[104:107], v[148:151], a[60:63]
    v_mfma_f32_16x16x32_bf16 a[56:59], v[108:111], v[152:155], a[56:59]
    v_mfma_f32_16x16x32_bf16 a[60:63], v[108:111], v[156:159], a[60:63]
    s_waitcnt lgkmcnt(0)
    v_mfma_f32_16x16x32_bf16 a[0:3], v[120:123], v[160:163], a[0:3]
    v_mfma_f32_16x16x32_bf16 a[4:7], v[120:123], v[164:167], a[4:7]
    v_mfma_f32_16x16x32_bf16 a[0:3], v[124:127], v[168:171], a[0:3]
    v_mfma_f32_16x16x32_bf16 a[4:7], v[124:127], v[172:175], a[4:7]
    v_mov_b32_dpp v120, v120 row_shl:1 row_mask:0xf bank_mask:0xf
    v_mfma_f32_16x16x32_bf16 a[8:11], v[128:131], v[160:163], a[8:11]
    v_mov_b32_dpp v121, v121 row_shl:1 row_mask:0xf bank_mask:0xf
    v_mfma_f32_16x16x32_bf16 a[12:15], v[128:131], v[164:167], a[12:15]
    v_mov_b32_dpp v122, v122 row_shl:1 row_mask:0xf bank_mask:0xf
    v_mfma_f32_16x16x32_bf16 a[8:11], v[132:135], v[168:171], a[8:11]
    v_mov_b32_dpp v123, v123 row_shl:1 row_mask:0xf bank_mask:0xf
    v_mfma_f32_16x16x32_bf16 a[12:15], v[132:135], v[172:175], a[12:15]
    v_mov_b32_dpp v124, v124 row_shl:1 row_mask:0xf bank_mask:0xf
    v_mfma_f32_16x16x32_bf16 a[16:19], v[136:139], v[160:163], a[16:19]
    v_mov_b32_dpp v125, v125 row_shl:1 row_mask:0xf bank_mask:0xf
    v_mfma_f32_16x16x32_bf16 a[20:23], v[136:139], v[164:167], a[20:23]
    v_mov_b32_dpp v126, v126 row_shl:1 row_mask:0xf bank_mask:0xf
    v_mfma_f32_16x16x32_bf16 a[16:19], v[140:143], v[168:171], a[16:19]
    v_mov_b32_dpp v127, v127 row_shl:1 row_mask:0xf bank_mask:0xf
    v_mfma_f32_16x16x32_bf16 a[20:23], v[140:143], v[172:175], a[20:23]
    s_mov_b64 exec, s[46:47]
    buffer_load_dwordx4 v[120:123], v1, s[12:15], s33 offen offset:1536
    buffer_load_dwordx4 v[124:127], v1, s[12:15], s33 offen offset:1600
    s_mov_b64 exec, -1
    v_mfma_f32_16x16x32_bf16 a[24:27], v[80:83], v[160:163], a[24:27]
    v_mfma_f32_16x16x32_bf16 a[28:31], v[80:83], v[164:167], a[28:31]
    s_add_u32 s37, s36, 2490368
    s_add_u32 m0, s28, 4096
    v_mfma_f32_16x16x32_bf16 a[24:27], v[84:87], v[168:171], a[24:27]
    buffer_load_dwordx4 v2, s[16:19], s37 offen offset:0 lds
    v_mfma_f32_16x16x32_bf16 a[28:31], v[84:87], v[172:175], a[28:31]
    buffer_load_dwordx4 v3, s[16:19], s37 offen offset:1024 lds
    v_mfma_f32_16x16x32_bf16 a[32:35], v[88:91], v[160:163], a[32:35]
    buffer_load_dwordx4 v4, s[16:19], s37 offen offset:2048 lds
    v_mfma_f32_16x16x32_bf16 a[36:39], v[88:91], v[164:167], a[36:39]
    buffer_load_dwordx4 v5, s[16:19], s37 offen offset:3072 lds
    v_mfma_f32_16x16x32_bf16 a[32:35], v[92:95], v[168:171], a[32:35]
    ds_read_b64_tr_b16 v[144:145], v6 offset:8192
    v_mfma_f32_16x16x32_bf16 a[36:39], v[92:95], v[172:175], a[36:39]
    ds_read_b64_tr_b16 v[146:147], v6 offset:8448
    v_mfma_f32_16x16x32_bf16 a[40:43], v[96:99], v[160:163], a[40:43]
    ds_read_b64_tr_b16 v[148:149], v7 offset:8192
    v_mfma_f32_16x16x32_bf16 a[44:47], v[96:99], v[164:167], a[44:47]
    ds_read_b64_tr_b16 v[150:151], v7 offset:8448
    v_mfma_f32_16x16x32_bf16 a[40:43], v[100:103], v[168:171], a[40:43]
    ds_read_b64_tr_b16 v[152:153], v6 offset:10240
    v_mfma_f32_16x16x32_bf16 a[44:47], v[100:103], v[172:175], a[44:47]
    ds_read_b64_tr_b16 v[154:155], v6 offset:10496
    v_mfma_f32_16x16x32_bf16 a[48:51], v[104:107], v[160:163], a[48:51]
    ds_read_b64_tr_b16 v[156:157], v7 offset:10240
    v_mfma_f32_16x16x32_bf16 a[52:55], v[104:107], v[164:167], a[52:55]
    ds_read_b64_tr_b16 v[158:159], v7 offset:10496
    v_mfma_f32_16x16x32_bf16 a[48:51], v[108:111], v[168:171], a[48:51]
    v_mfma_f32_16x16x32_bf16 a[52:55], v[108:111], v[172:175], a[52:55]
    s_waitcnt vmcnt(10)
    v_mfma_f32_16x16x32_bf16 a[56:59], v[112:115], v[160:163], a[56:59]
    v_mfma_f32_16x16x32_bf16 a[60:63], v[112:115], v[164:167], a[60:63]
    v_mfma_f32_16x16x32_bf16 a[56:59], v[116:119], v[168:171], a[56:59]
    v_mfma_f32_16x16x32_bf16 a[60:63], v[116:119], v[172:175], a[60:63]
    s_waitcnt lgkmcnt(0)
    v_mfma_f32_16x16x32_bf16 a[0:3], v[128:131], v[144:147], a[0:3]
    v_mfma_f32_16x16x32_bf16 a[4:7], v[128:131], v[148:151], a[4:7]
    v_mfma_f32_16x16x32_bf16 a[0:3], v[132:135], v[152:155], a[0:3]
    v_mfma_f32_16x16x32_bf16 a[4:7], v[132:135], v[156:159], a[4:7]
    v_mov_b32_dpp v128, v128 row_shl:1 row_mask:0xf bank_mask:0xf
    v_mfma_f32_16x16x32_bf16 a[8:11], v[136:139], v[144:147], a[8:11]
    v_mov_b32_dpp v129, v129 row_shl:1 row_mask:0xf bank_mask:0xf
    v_mfma_f32_16x16x32_bf16 a[12:15], v[136:139], v[148:151], a[12:15]
    v_mov_b32_dpp v130, v130 row_shl:1 row_mask:0xf bank_mask:0xf
    v_mfma_f32_16x16x32_bf16 a[8:11], v[140:143], v[152:155], a[8:11]
    v_mov_b32_dpp v131, v131 row_shl:1 row_mask:0xf bank_mask:0xf
    v_mfma_f32_16x16x32_bf16 a[12:15], v[140:143], v[156:159], a[12:15]
    v_mov_b32_dpp v132, v132 row_shl:1 row_mask:0xf bank_mask:0xf
    v_mfma_f32_16x16x32_bf16 a[16:19], v[80:83], v[144:147], a[16:19]
    v_mov_b32_dpp v133, v133 row_shl:1 row_mask:0xf bank_mask:0xf
    v_mfma_f32_16x16x32_bf16 a[20:23], v[80:83], v[148:151], a[20:23]
    v_mov_b32_dpp v134, v134 row_shl:1 row_mask:0xf bank_mask:0xf
    v_mfma_f32_16x16x32_bf16 a[16:19], v[84:87], v[152:155], a[16:19]
    v_mov_b32_dpp v135, v135 row_shl:1 row_mask:0xf bank_mask:0xf
    v_mfma_f32_16x16x32_bf16 a[20:23], v[84:87], v[156:159], a[20:23]
    s_mov_b64 exec, s[46:47]
    buffer_load_dwordx4 v[128:131], v1, s[12:15], s33 offen offset:2560
    buffer_load_dwordx4 v[132:135], v1, s[12:15], s33 offen offset:2624
    s_mov_b64 exec, -1
    v_mfma_f32_16x16x32_bf16 a[24:27], v[88:91], v[144:147], a[24:27]
    v_mfma_f32_16x16x32_bf16 a[28:31], v[88:91], v[148:151], a[28:31]
    s_add_u32 s37, s36, 2752512
    s_add_u32 m0, s28, 8192
    v_mfma_f32_16x16x32_bf16 a[24:27], v[92:95], v[152:155], a[24:27]
    buffer_load_dwordx4 v2, s[16:19], s37 offen offset:0 lds
    v_mfma_f32_16x16x32_bf16 a[28:31], v[92:95], v[156:159], a[28:31]
    buffer_load_dwordx4 v3, s[16:19], s37 offen offset:1024 lds
    v_mfma_f32_16x16x32_bf16 a[32:35], v[96:99], v[144:147], a[32:35]
    buffer_load_dwordx4 v4, s[16:19], s37 offen offset:2048 lds
    v_mfma_f32_16x16x32_bf16 a[36:39], v[96:99], v[148:151], a[36:39]
    buffer_load_dwordx4 v5, s[16:19], s37 offen offset:3072 lds
    v_mfma_f32_16x16x32_bf16 a[32:35], v[100:103], v[152:155], a[32:35]
    ds_read_b64_tr_b16 v[160:161], v6 offset:12288
    v_mfma_f32_16x16x32_bf16 a[36:39], v[100:103], v[156:159], a[36:39]
    ds_read_b64_tr_b16 v[162:163], v6 offset:12544
    v_mfma_f32_16x16x32_bf16 a[40:43], v[104:107], v[144:147], a[40:43]
    ds_read_b64_tr_b16 v[164:165], v7 offset:12288
    v_mfma_f32_16x16x32_bf16 a[44:47], v[104:107], v[148:151], a[44:47]
    ds_read_b64_tr_b16 v[166:167], v7 offset:12544
    v_mfma_f32_16x16x32_bf16 a[40:43], v[108:111], v[152:155], a[40:43]
    ds_read_b64_tr_b16 v[168:169], v6 offset:14336
    v_mfma_f32_16x16x32_bf16 a[44:47], v[108:111], v[156:159], a[44:47]
    ds_read_b64_tr_b16 v[170:171], v6 offset:14592
    v_mfma_f32_16x16x32_bf16 a[48:51], v[112:115], v[144:147], a[48:51]
    ds_read_b64_tr_b16 v[172:173], v7 offset:14336
    v_mfma_f32_16x16x32_bf16 a[52:55], v[112:115], v[148:151], a[52:55]
    ds_read_b64_tr_b16 v[174:175], v7 offset:14592
    v_mfma_f32_16x16x32_bf16 a[48:51], v[116:119], v[152:155], a[48:51]
    v_mfma_f32_16x16x32_bf16 a[52:55], v[116:119], v[156:159], a[52:55]
    s_waitcnt vmcnt(10)
    v_mfma_f32_16x16x32_bf16 a[56:59], v[120:123], v[144:147], a[56:59]
    v_mfma_f32_16x16x32_bf16 a[60:63], v[120:123], v[148:151], a[60:63]
    v_mfma_f32_16x16x32_bf16 a[56:59], v[124:127], v[152:155], a[56:59]
    v_mfma_f32_16x16x32_bf16 a[60:63], v[124:127], v[156:159], a[60:63]
    s_waitcnt lgkmcnt(0)
    v_mfma_f32_16x16x32_bf16 a[0:3], v[136:139], v[160:163], a[0:3]
    v_mfma_f32_16x16x32_bf16 a[4:7], v[136:139], v[164:167], a[4:7]
    v_mfma_f32_16x16x32_bf16 a[0:3], v[140:143], v[168:171], a[0:3]
    v_mfma_f32_16x16x32_bf16 a[4:7], v[140:143], v[172:175], a[4:7]
    v_mov_b32_dpp v136, v136 row_shl:1 row_mask:0xf bank_mask:0xf
    v_mfma_f32_16x16x32_bf16 a[8:11], v[80:83], v[160:163], a[8:11]
    v_mov_b32_dpp v137, v137 row_shl:1 row_mask:0xf bank_mask:0xf
    v_mfma_f32_16x16x32_bf16 a[12:15], v[80:83], v[164:167], a[12:15]
    v_mov_b32_dpp v138, v138 row_shl:1 row_mask:0xf bank_mask:0xf
    v_mfma_f32_16x16x32_bf16 a[8:11], v[84:87], v[168:171], a[8:11]
    v_mov_b32_dpp v139, v139 row_shl:1 row_mask:0xf bank_mask:0xf
    v_mfma_f32_16x16x32_bf16 a[12:15], v[84:87], v[172:175], a[12:15]
    v_mov_b32_dpp v140, v140 row_shl:1 row_mask:0xf bank_mask:0xf
    v_mfma_f32_16x16x32_bf16 a[16:19], v[88:91], v[160:163], a[16:19]
    v_mov_b32_dpp v141, v141 row_shl:1 row_mask:0xf bank_mask:0xf
    v_mfma_f32_16x16x32_bf16 a[20:23], v[88:91], v[164:167], a[20:23]
    v_mov_b32_dpp v142, v142 row_shl:1 row_mask:0xf bank_mask:0xf
    v_mfma_f32_16x16x32_bf16 a[16:19], v[92:95], v[168:171], a[16:19]
    v_mov_b32_dpp v143, v143 row_shl:1 row_mask:0xf bank_mask:0xf
    v_mfma_f32_16x16x32_bf16 a[20:23], v[92:95], v[172:175], a[20:23]
    s_mov_b64 exec, s[46:47]
    buffer_load_dwordx4 v[136:139], v1, s[12:15], s33 offen offset:3584
    buffer_load_dwordx4 v[140:143], v1, s[12:15], s33 offen offset:3648
    s_mov_b64 exec, -1
    v_mfma_f32_16x16x32_bf16 a[24:27], v[96:99], v[160:163], a[24:27]
    v_mfma_f32_16x16x32_bf16 a[28:31], v[96:99], v[164:167], a[28:31]
    s_add_u32 s37, s36, 3014656
    s_add_u32 m0, s28, 12288
    v_mfma_f32_16x16x32_bf16 a[24:27], v[100:103], v[168:171], a[24:27]
    buffer_load_dwordx4 v2, s[16:19], s37 offen offset:0 lds
    v_mfma_f32_16x16x32_bf16 a[28:31], v[100:103], v[172:175], a[28:31]
    buffer_load_dwordx4 v3, s[16:19], s37 offen offset:1024 lds
    v_mfma_f32_16x16x32_bf16 a[32:35], v[104:107], v[160:163], a[32:35]
    buffer_load_dwordx4 v4, s[16:19], s37 offen offset:2048 lds
    v_mfma_f32_16x16x32_bf16 a[36:39], v[104:107], v[164:167], a[36:39]
    buffer_load_dwordx4 v5, s[16:19], s37 offen offset:3072 lds
    v_mfma_f32_16x16x32_bf16 a[32:35], v[108:111], v[168:171], a[32:35]
    ds_read_b64_tr_b16 v[144:145], v6 offset:0
    v_mfma_f32_16x16x32_bf16 a[36:39], v[108:111], v[172:175], a[36:39]
    ds_read_b64_tr_b16 v[146:147], v6 offset:256
    v_mfma_f32_16x16x32_bf16 a[40:43], v[112:115], v[160:163], a[40:43]
    ds_read_b64_tr_b16 v[148:149], v7 offset:0
    v_mfma_f32_16x16x32_bf16 a[44:47], v[112:115], v[164:167], a[44:47]
    ds_read_b64_tr_b16 v[150:151], v7 offset:256
    v_mfma_f32_16x16x32_bf16 a[40:43], v[116:119], v[168:171], a[40:43]
    ds_read_b64_tr_b16 v[152:153], v6 offset:2048
    v_mfma_f32_16x16x32_bf16 a[44:47], v[116:119], v[172:175], a[44:47]
    ds_read_b64_tr_b16 v[154:155], v6 offset:2304
    v_mfma_f32_16x16x32_bf16 a[48:51], v[120:123], v[160:163], a[48:51]
    ds_read_b64_tr_b16 v[156:157], v7 offset:2048
    v_mfma_f32_16x16x32_bf16 a[52:55], v[120:123], v[164:167], a[52:55]
    ds_read_b64_tr_b16 v[158:159], v7 offset:2304
    v_mfma_f32_16x16x32_bf16 a[48:51], v[124:127], v[168:171], a[48:51]
    v_mfma_f32_16x16x32_bf16 a[52:55], v[124:127], v[172:175], a[52:55]
    s_waitcnt vmcnt(10)
    v_mfma_f32_16x16x32_bf16 a[56:59], v[128:131], v[160:163], a[56:59]
    v_mfma_f32_16x16x32_bf16 a[60:63], v[128:131], v[164:167], a[60:63]
    v_mfma_f32_16x16x32_bf16 a[56:59], v[132:135], v[168:171], a[56:59]
    v_mfma_f32_16x16x32_bf16 a[60:63], v[132:135], v[172:175], a[60:63]
    s_waitcnt lgkmcnt(0)
    v_mfma_f32_16x16x32_bf16 a[0:3], v[80:83], v[144:147], a[0:3]
    v_mfma_f32_16x16x32_bf16 a[4:7], v[80:83], v[148:151], a[4:7]
    v_mfma_f32_16x16x32_bf16 a[0:3], v[84:87], v[152:155], a[0:3]
    v_mfma_f32_16x16x32_bf16 a[4:7], v[84:87], v[156:159], a[4:7]
    v_mov_b32_dpp v80, v80 row_shl:1 row_mask:0xf bank_mask:0xf
    v_mfma_f32_16x16x32_bf16 a[8:11], v[88:91], v[144:147], a[8:11]
    v_mov_b32_dpp v81, v81 row_shl:1 row_mask:0xf bank_mask:0xf
    v_mfma_f32_16x16x32_bf16 a[12:15], v[88:91], v[148:151], a[12:15]
    v_mov_b32_dpp v82, v82 row_shl:1 row_mask:0xf bank_mask:0xf
    v_mfma_f32_16x16x32_bf16 a[8:11], v[92:95], v[152:155], a[8:11]
    v_mov_b32_dpp v83, v83 row_shl:1 row_mask:0xf bank_mask:0xf
    v_mfma_f32_16x16x32_bf16 a[12:15], v[92:95], v[156:159], a[12:15]
    v_mov_b32_dpp v84, v84 row_shl:1 row_mask:0xf bank_mask:0xf
    v_mfma_f32_16x16x32_bf16 a[16:19], v[96:99], v[144:147], a[16:19]
    v_mov_b32_dpp v85, v85 row_shl:1 row_mask:0xf bank_mask:0xf
    v_mfma_f32_16x16x32_bf16 a[20:23], v[96:99], v[148:151], a[20:23]
    v_mov_b32_dpp v86, v86 row_shl:1 row_mask:0xf bank_mask:0xf
    v_mfma_f32_16x16x32_bf16 a[16:19], v[100:103], v[152:155], a[16:19]
    v_mov_b32_dpp v87, v87 row_shl:1 row_mask:0xf bank_mask:0xf
    v_mfma_f32_16x16x32_bf16 a[20:23], v[100:103], v[156:159], a[20:23]
    s_mov_b64 exec, s[46:47]
    buffer_load_dwordx4 v[80:83], v1, s[12:15], s34 offen offset:512
    buffer_load_dwordx4 v[84:87], v1, s[12:15], s34 offen offset:576
    s_mov_b64 exec, -1
    v_mfma_f32_16x16x32_bf16 a[24:27], v[104:107], v[144:147], a[24:27]
    v_mfma_f32_16x16x32_bf16 a[28:31], v[104:107], v[148:151], a[28:31]
    s_add_u32 s37, s36, 3276800
    s_add_u32 m0, s28, 0
    v_mfma_f32_16x16x32_bf16 a[24:27], v[108:111], v[152:155], a[24:27]
    buffer_load_dwordx4 v2, s[16:19], s37 offen offset:0 lds
    v_mfma_f32_16x16x32_bf16 a[28:31], v[108:111], v[156:159], a[28:31]
    buffer_load_dwordx4 v3, s[16:19], s37 offen offset:1024 lds
    v_mfma_f32_16x16x32_bf16 a[32:35], v[112:115], v[144:147], a[32:35]
    buffer_load_dwordx4 v4, s[16:19], s37 offen offset:2048 lds
    v_mfma_f32_16x16x32_bf16 a[36:39], v[112:115], v[148:151], a[36:39]
    buffer_load_dwordx4 v5, s[16:19], s37 offen offset:3072 lds
    v_mfma_f32_16x16x32_bf16 a[32:35], v[116:119], v[152:155], a[32:35]
    ds_read_b64_tr_b16 v[160:161], v6 offset:4096
    v_mfma_f32_16x16x32_bf16 a[36:39], v[116:119], v[156:159], a[36:39]
    ds_read_b64_tr_b16 v[162:163], v6 offset:4352
    v_mfma_f32_16x16x32_bf16 a[40:43], v[120:123], v[144:147], a[40:43]
    ds_read_b64_tr_b16 v[164:165], v7 offset:4096
    v_mfma_f32_16x16x32_bf16 a[44:47], v[120:123], v[148:151], a[44:47]
    ds_read_b64_tr_b16 v[166:167], v7 offset:4352
    v_mfma_f32_16x16x32_bf16 a[40:43], v[124:127], v[152:155], a[40:43]
    ds_read_b64_tr_b16 v[168:169], v6 offset:6144
    v_mfma_f32_16x16x32_bf16 a[44:47], v[124:127], v[156:159], a[44:47]
    ds_read_b64_tr_b16 v[170:171], v6 offset:6400
    v_mfma_f32_16x16x32_bf16 a[48:51], v[128:131], v[144:147], a[48:51]
    ds_read_b64_tr_b16 v[172:173], v7 offset:6144
    v_mfma_f32_16x16x32_bf16 a[52:55], v[128:131], v[148:151], a[52:55]
    ds_read_b64_tr_b16 v[174:175], v7 offset:6400
    v_mfma_f32_16x16x32_bf16 a[48:51], v[132:135], v[152:155], a[48:51]
    v_mfma_f32_16x16x32_bf16 a[52:55], v[132:135], v[156:159], a[52:55]
    s_waitcnt vmcnt(10)
    v_mfma_f32_16x16x32_bf16 a[56:59], v[136:139], v[144:147], a[56:59]
    v_mfma_f32_16x16x32_bf16 a[60:63], v[136:139], v[148:151], a[60:63]
    v_mfma_f32_16x16x32_bf16 a[56:59], v[140:143], v[152:155], a[56:59]
    v_mfma_f32_16x16x32_bf16 a[60:63], v[140:143], v[156:159], a[60:63]
    s_waitcnt lgkmcnt(0)
    v_mfma_f32_16x16x32_bf16 a[0:3], v[88:91], v[160:163], a[0:3]
    v_mfma_f32_16x16x32_bf16 a[4:7], v[88:91], v[164:167], a[4:7]
    v_mfma_f32_16x16x32_bf16 a[0:3], v[92:95], v[168:171], a[0:3]
    v_mfma_f32_16x16x32_bf16 a[4:7], v[92:95], v[172:175], a[4:7]
    v_mov_b32_dpp v88, v88 row_shl:1 row_mask:0xf bank_mask:0xf
    v_mfma_f32_16x16x32_bf16 a[8:11], v[96:99], v[160:163], a[8:11]
    v_mov_b32_dpp v89, v89 row_shl:1 row_mask:0xf bank_mask:0xf
    v_mfma_f32_16x16x32_bf16 a[12:15], v[96:99], v[164:167], a[12:15]
    v_mov_b32_dpp v90, v90 row_shl:1 row_mask:0xf bank_mask:0xf
    v_mfma_f32_16x16x32_bf16 a[8:11], v[100:103], v[168:171], a[8:11]
    v_mov_b32_dpp v91, v91 row_shl:1 row_mask:0xf bank_mask:0xf
    v_mfma_f32_16x16x32_bf16 a[12:15], v[100:103], v[172:175], a[12:15]
    v_mov_b32_dpp v92, v92 row_shl:1 row_mask:0xf bank_mask:0xf
    v_mfma_f32_16x16x32_bf16 a[16:19], v[104:107], v[160:163], a[16:19]
    v_mov_b32_dpp v93, v93 row_shl:1 row_mask:0xf bank_mask:0xf
    v_mfma_f32_16x16x32_bf16 a[20:23], v[104:107], v[164:167], a[20:23]
    v_mov_b32_dpp v94, v94 row_shl:1 row_mask:0xf bank_mask:0xf
    v_mfma_f32_16x16x32_bf16 a[16:19], v[108:111], v[168:171], a[16:19]
    v_mov_b32_dpp v95, v95 row_shl:1 row_mask:0xf bank_mask:0xf
    v_mfma_f32_16x16x32_bf16 a[20:23], v[108:111], v[172:175], a[20:23]
    s_mov_b64 exec, s[46:47]
    buffer_load_dwordx4 v[88:91], v1, s[12:15], s34 offen offset:1536
    buffer_load_dwordx4 v[92:95], v1, s[12:15], s34 offen offset:1600
    s_mov_b64 exec, -1
    v_mfma_f32_16x16x32_bf16 a[24:27], v[112:115], v[160:163], a[24:27]
    v_mfma_f32_16x16x32_bf16 a[28:31], v[112:115], v[164:167], a[28:31]
    s_add_u32 s37, s36, 3538944
    s_add_u32 m0, s28, 4096
    v_mfma_f32_16x16x32_bf16 a[24:27], v[116:119], v[168:171], a[24:27]
    buffer_load_dwordx4 v2, s[16:19], s37 offen offset:0 lds
    v_mfma_f32_16x16x32_bf16 a[28:31], v[116:119], v[172:175], a[28:31]
    buffer_load_dwordx4 v3, s[16:19], s37 offen offset:1024 lds
    v_mfma_f32_16x16x32_bf16 a[32:35], v[120:123], v[160:163], a[32:35]
    buffer_load_dwordx4 v4, s[16:19], s37 offen offset:2048 lds
    v_mfma_f32_16x16x32_bf16 a[36:39], v[120:123], v[164:167], a[36:39]
    buffer_load_dwordx4 v5, s[16:19], s37 offen offset:3072 lds
    v_mfma_f32_16x16x32_bf16 a[32:35], v[124:127], v[168:171], a[32:35]
    ds_read_b64_tr_b16 v[144:145], v6 offset:8192
    v_mfma_f32_16x16x32_bf16 a[36:39], v[124:127], v[172:175], a[36:39]
    ds_read_b64_tr_b16 v[146:147], v6 offset:8448
    v_mfma_f32_16x16x32_bf16 a[40:43], v[128:131], v[160:163], a[40:43]
    ds_read_b64_tr_b16 v[148:149], v7 offset:8192
    v_mfma_f32_16x16x32_bf16 a[44:47], v[128:131], v[164:167], a[44:47]
    ds_read_b64_tr_b16 v[150:151], v7 offset:8448
    v_mfma_f32_16x16x32_bf16 a[40:43], v[132:135], v[168:171], a[40:43]
    ds_read_b64_tr_b16 v[152:153], v6 offset:10240
    v_mfma_f32_16x16x32_bf16 a[44:47], v[132:135], v[172:175], a[44:47]
    ds_read_b64_tr_b16 v[154:155], v6 offset:10496
    v_mfma_f32_16x16x32_bf16 a[48:51], v[136:139], v[160:163], a[48:51]
    ds_read_b64_tr_b16 v[156:157], v7 offset:10240
    v_mfma_f32_16x16x32_bf16 a[52:55], v[136:139], v[164:167], a[52:55]
    ds_read_b64_tr_b16 v[158:159], v7 offset:10496
    v_mfma_f32_16x16x32_bf16 a[48:51], v[140:143], v[168:171], a[48:51]
    v_mfma_f32_16x16x32_bf16 a[52:55], v[140:143], v[172:175], a[52:55]
    s_waitcnt vmcnt(10)
    v_mfma_f32_16x16x32_bf16 a[56:59], v[80:83], v[160:163], a[56:59]
    v_mfma_f32_16x16x32_bf16 a[60:63], v[80:83], v[164:167], a[60:63]
    v_mfma_f32_16x16x32_bf16 a[56:59], v[84:87], v[168:171], a[56:59]
    v_mfma_f32_16x16x32_bf16 a[60:63], v[84:87], v[172:175], a[60:63]
    s_waitcnt lgkmcnt(0)
    v_mfma_f32_16x16x32_bf16 a[0:3], v[96:99], v[144:147], a[0:3]
    v_mfma_f32_16x16x32_bf16 a[4:7], v[96:99], v[148:151], a[4:7]
    v_mfma_f32_16x16x32_bf16 a[0:3], v[100:103], v[152:155], a[0:3]
    v_mfma_f32_16x16x32_bf16 a[4:7], v[100:103], v[156:159], a[4:7]
    v_mov_b32_dpp v96, v96 row_shl:1 row_mask:0xf bank_mask:0xf
    v_mfma_f32_16x16x32_bf16 a[8:11], v[104:107], v[144:147], a[8:11]
    v_mov_b32_dpp v97, v97 row_shl:1 row_mask:0xf bank_mask:0xf
    v_mfma_f32_16x16x32_bf16 a[12:15], v[104:107], v[148:151], a[12:15]
    v_mov_b32_dpp v98, v98 row_shl:1 row_mask:0xf bank_mask:0xf
    v_mfma_f32_16x16x32_bf16 a[8:11], v[108:111], v[152:155], a[8:11]
    v_mov_b32_dpp v99, v99 row_shl:1 row_mask:0xf bank_mask:0xf
    v_mfma_f32_16x16x32_bf16 a[12:15], v[108:111], v[156:159], a[12:15]
    v_mov_b32_dpp v100, v100 row_shl:1 row_mask:0xf bank_mask:0xf
    v_mfma_f32_16x16x32_bf16 a[16:19], v[112:115], v[144:147], a[16:19]
    v_mov_b32_dpp v101, v101 row_shl:1 row_mask:0xf bank_mask:0xf
    v_mfma_f32_16x16x32_bf16 a[20:23], v[112:115], v[148:151], a[20:23]
    v_mov_b32_dpp v102, v102 row_shl:1 row_mask:0xf bank_mask:0xf
    v_mfma_f32_16x16x32_bf16 a[16:19], v[116:119], v[152:155], a[16:19]
    v_mov_b32_dpp v103, v103 row_shl:1 row_mask:0xf bank_mask:0xf
    v_mfma_f32_16x16x32_bf16 a[20:23], v[116:119], v[156:159], a[20:23]
    s_mov_b64 exec, s[46:47]
    buffer_load_dwordx4 v[96:99], v1, s[12:15], s34 offen offset:2560
    buffer_load_dwordx4 v[100:103], v1, s[12:15], s34 offen offset:2624
    s_mov_b64 exec, -1
    v_mfma_f32_16x16x32_bf16 a[24:27], v[120:123], v[144:147], a[24:27]
    v_mfma_f32_16x16x32_bf16 a[28:31], v[120:123], v[148:151], a[28:31]
    s_add_u32 s37, s36, 3801088
    s_add_u32 m0, s28, 8192
    v_mfma_f32_16x16x32_bf16 a[24:27], v[124:127], v[152:155], a[24:27]
    buffer_load_dwordx4 v2, s[16:19], s37 offen offset:0 lds
    v_mfma_f32_16x16x32_bf16 a[28:31], v[124:127], v[156:159], a[28:31]
    buffer_load_dwordx4 v3, s[16:19], s37 offen offset:1024 lds
    v_mfma_f32_16x16x32_bf16 a[32:35], v[128:131], v[144:147], a[32:35]
    buffer_load_dwordx4 v4, s[16:19], s37 offen offset:2048 lds
    v_mfma_f32_16x16x32_bf16 a[36:39], v[128:131], v[148:151], a[36:39]
    buffer_load_dwordx4 v5, s[16:19], s37 offen offset:3072 lds
    v_mfma_f32_16x16x32_bf16 a[32:35], v[132:135], v[152:155], a[32:35]
    ds_read_b64_tr_b16 v[160:161], v6 offset:12288
    v_mfma_f32_16x16x32_bf16 a[36:39], v[132:135], v[156:159], a[36:39]
    ds_read_b64_tr_b16 v[162:163], v6 offset:12544
    v_mfma_f32_16x16x32_bf16 a[40:43], v[136:139], v[144:147], a[40:43]
    ds_read_b64_tr_b16 v[164:165], v7 offset:12288
    v_mfma_f32_16x16x32_bf16 a[44:47], v[136:139], v[148:151], a[44:47]
    ds_read_b64_tr_b16 v[166:167], v7 offset:12544
    v_mfma_f32_16x16x32_bf16 a[40:43], v[140:143], v[152:155], a[40:43]
    ds_read_b64_tr_b16 v[168:169], v6 offset:14336
    v_mfma_f32_16x16x32_bf16 a[44:47], v[140:143], v[156:159], a[44:47]
    ds_read_b64_tr_b16 v[170:171], v6 offset:14592
    v_mfma_f32_16x16x32_bf16 a[48:51], v[80:83], v[144:147], a[48:51]
    ds_read_b64_tr_b16 v[172:173], v7 offset:14336
    v_mfma_f32_16x16x32_bf16 a[52:55], v[80:83], v[148:151], a[52:55]
    ds_read_b64_tr_b16 v[174:175], v7 offset:14592
    v_mfma_f32_16x16x32_bf16 a[48:51], v[84:87], v[152:155], a[48:51]
    v_mfma_f32_16x16x32_bf16 a[52:55], v[84:87], v[156:159], a[52:55]
    s_waitcnt vmcnt(10)
    v_mfma_f32_16x16x32_bf16 a[56:59], v[88:91], v[144:147], a[56:59]
    v_mfma_f32_16x16x32_bf16 a[60:63], v[88:91], v[148:151], a[60:63]
    v_mfma_f32_16x16x32_bf16 a[56:59], v[92:95], v[152:155], a[56:59]
    v_mfma_f32_16x16x32_bf16 a[60:63], v[92:95], v[156:159], a[60:63]
    s_waitcnt lgkmcnt(0)
    v_mfma_f32_16x16x32_bf16 a[0:3], v[104:107], v[160:163], a[0:3]
    v_mfma_f32_16x16x32_bf16 a[4:7], v[104:107], v[164:167], a[4:7]
    v_mfma_f32_16x16x32_bf16 a[0:3], v[108:111], v[168:171], a[0:3]
    v_mfma_f32_16x16x32_bf16 a[4:7], v[108:111], v[172:175], a[4:7]
    v_mov_b32_dpp v104, v104 row_shl:1 row_mask:0xf bank_mask:0xf
    v_mfma_f32_16x16x32_bf16 a[8:11], v[112:115], v[160:163], a[8:11]
    v_mov_b32_dpp v105, v105 row_shl:1 row_mask:0xf bank_mask:0xf
    v_mfma_f32_16x16x32_bf16 a[12:15], v[112:115], v[164:167], a[12:15]
    v_mov_b32_dpp v106, v106 row_shl:1 row_mask:0xf bank_mask:0xf
    v_mfma_f32_16x16x32_bf16 a[8:11], v[116:119], v[168:171], a[8:11]
    v_mov_b32_dpp v107, v107 row_shl:1 row_mask:0xf bank_mask:0xf
    v_mfma_f32_16x16x32_bf16 a[12:15], v[116:119], v[172:175], a[12:15]
    v_mov_b32_dpp v108, v108 row_shl:1 row_mask:0xf bank_mask:0xf
    v_mfma_f32_16x16x32_bf16 a[16:19], v[120:123], v[160:163], a[16:19]
    v_mov_b32_dpp v109, v109 row_shl:1 row_mask:0xf bank_mask:0xf
    v_mfma_f32_16x16x32_bf16 a[20:23], v[120:123], v[164:167], a[20:23]
    v_mov_b32_dpp v110, v110 row_shl:1 row_mask:0xf bank_mask:0xf
    v_mfma_f32_16x16x32_bf16 a[16:19], v[124:127], v[168:171], a[16:19]
    v_mov_b32_dpp v111, v111 row_shl:1 row_mask:0xf bank_mask:0xf
    v_mfma_f32_16x16x32_bf16 a[20:23], v[124:127], v[172:175], a[20:23]
    s_mov_b64 exec, s[46:47]
    buffer_load_dwordx4 v[104:107], v1, s[12:15], s34 offen offset:3584
    buffer_load_dwordx4 v[108:111], v1, s[12:15], s34 offen offset:3648
    s_mov_b64 exec, -1
    v_mfma_f32_16x16x32_bf16 a[24:27], v[128:131], v[160:163], a[24:27]
    v_mfma_f32_16x16x32_bf16 a[28:31], v[128:131], v[164:167], a[28:31]
    v_mfma_f32_16x16x32_bf16 a[24:27], v[132:135], v[168:171], a[24:27]
    v_mfma_f32_16x16x32_bf16 a[28:31], v[132:135], v[172:175], a[28:31]
    v_mfma_f32_16x16x32_bf16 a[32:35], v[136:139], v[160:163], a[32:35]
    v_mfma_f32_16x16x32_bf16 a[36:39], v[136:139], v[164:167], a[36:39]
    v_mfma_f32_16x16x32_bf16 a[32:35], v[140:143], v[168:171], a[32:35]
    ds_read_b64_tr_b16 v[144:145], v6 offset:0
    v_mfma_f32_16x16x32_bf16 a[36:39], v[140:143], v[172:175], a[36:39]
    ds_read_b64_tr_b16 v[146:147], v6 offset:256
    v_mfma_f32_16x16x32_bf16 a[40:43], v[80:83], v[160:163], a[40:43]
    ds_read_b64_tr_b16 v[148:149], v7 offset:0
    v_mfma_f32_16x16x32_bf16 a[44:47], v[80:83], v[164:167], a[44:47]
    ds_read_b64_tr_b16 v[150:151], v7 offset:256
    v_mfma_f32_16x16x32_bf16 a[40:43], v[84:87], v[168:171], a[40:43]
    ds_read_b64_tr_b16 v[152:153], v6 offset:2048
    v_mfma_f32_16x16x32_bf16 a[44:47], v[84:87], v[172:175], a[44:47]
    ds_read_b64_tr_b16 v[154:155], v6 offset:2304
    v_mfma_f32_16x16x32_bf16 a[48:51], v[88:91], v[160:163], a[48:51]
    ds_read_b64_tr_b16 v[156:157], v7 offset:2048
    v_mfma_f32_16x16x32_bf16 a[52:55], v[88:91], v[164:167], a[52:55]
    ds_read_b64_tr_b16 v[158:159], v7 offset:2304
    v_mfma_f32_16x16x32_bf16 a[48:51], v[92:95], v[168:171], a[48:51]
    v_mfma_f32_16x16x32_bf16 a[52:55], v[92:95], v[172:175], a[52:55]
    s_waitcnt vmcnt(6)
    v_mfma_f32_16x16x32_bf16 a[56:59], v[96:99], v[160:163], a[56:59]
    v_mfma_f32_16x16x32_bf16 a[60:63], v[96:99], v[164:167], a[60:63]
    v_mfma_f32_16x16x32_bf16 a[56:59], v[100:103], v[168:171], a[56:59]
    v_mfma_f32_16x16x32_bf16 a[60:63], v[100:103], v[172:175], a[60:63]
    s_waitcnt lgkmcnt(0)
    v_mfma_f32_16x16x32_bf16 a[0:3], v[112:115], v[144:147], a[0:3]
    v_mfma_f32_16x16x32_bf16 a[4:7], v[112:115], v[148:151], a[4:7]
    v_mfma_f32_16x16x32_bf16 a[0:3], v[116:119], v[152:155], a[0:3]
    v_mfma_f32_16x16x32_bf16 a[4:7], v[116:119], v[156:159], a[4:7]
    v_mov_b32_dpp v112, v112 row_shl:1 row_mask:0xf bank_mask:0xf
    v_mfma_f32_16x16x32_bf16 a[8:11], v[120:123], v[144:147], a[8:11]
    v_mov_b32_dpp v113, v113 row_shl:1 row_mask:0xf bank_mask:0xf
    v_mfma_f32_16x16x32_bf16 a[12:15], v[120:123], v[148:151], a[12:15]
    v_mov_b32_dpp v114, v114 row_shl:1 row_mask:0xf bank_mask:0xf
    v_mfma_f32_16x16x32_bf16 a[8:11], v[124:127], v[152:155], a[8:11]
    v_mov_b32_dpp v115, v115 row_shl:1 row_mask:0xf bank_mask:0xf
    v_mfma_f32_16x16x32_bf16 a[12:15], v[124:127], v[156:159], a[12:15]
    v_mov_b32_dpp v116, v116 row_shl:1 row_mask:0xf bank_mask:0xf
    v_mfma_f32_16x16x32_bf16 a[16:19], v[128:131], v[144:147], a[16:19]
    v_mov_b32_dpp v117, v117 row_shl:1 row_mask:0xf bank_mask:0xf
    v_mfma_f32_16x16x32_bf16 a[20:23], v[128:131], v[148:151], a[20:23]
    v_mov_b32_dpp v118, v118 row_shl:1 row_mask:0xf bank_mask:0xf
    v_mfma_f32_16x16x32_bf16 a[16:19], v[132:135], v[152:155], a[16:19]
    v_mov_b32_dpp v119, v119 row_shl:1 row_mask:0xf bank_mask:0xf
    v_mfma_f32_16x16x32_bf16 a[20:23], v[132:135], v[156:159], a[20:23]
    s_mov_b64 exec, s[46:47]
    buffer_load_dwordx4 v[112:115], v1, s[12:15], s35 offen offset:512
    buffer_load_dwordx4 v[116:119], v1, s[12:15], s35 offen offset:576
    s_mov_b64 exec, -1
    v_mfma_f32_16x16x32_bf16 a[24:27], v[136:139], v[144:147], a[24:27]
    v_mfma_f32_16x16x32_bf16 a[28:31], v[136:139], v[148:151], a[28:31]
    v_mfma_f32_16x16x32_bf16 a[24:27], v[140:143], v[152:155], a[24:27]
    v_mfma_f32_16x16x32_bf16 a[28:31], v[140:143], v[156:159], a[28:31]
    v_mfma_f32_16x16x32_bf16 a[32:35], v[80:83], v[144:147], a[32:35]
    v_mfma_f32_16x16x32_bf16 a[36:39], v[80:83], v[148:151], a[36:39]
    v_mfma_f32_16x16x32_bf16 a[32:35], v[84:87], v[152:155], a[32:35]
    ds_read_b64_tr_b16 v[160:161], v6 offset:4096
    v_mfma_f32_16x16x32_bf16 a[36:39], v[84:87], v[156:159], a[36:39]
    ds_read_b64_tr_b16 v[162:163], v6 offset:4352
    v_mfma_f32_16x16x32_bf16 a[40:43], v[88:91], v[144:147], a[40:43]
    ds_read_b64_tr_b16 v[164:165], v7 offset:4096
    v_mfma_f32_16x16x32_bf16 a[44:47], v[88:91], v[148:151], a[44:47]
    ds_read_b64_tr_b16 v[166:167], v7 offset:4352
    v_mfma_f32_16x16x32_bf16 a[40:43], v[92:95], v[152:155], a[40:43]
    ds_read_b64_tr_b16 v[168:169], v6 offset:6144
    v_mfma_f32_16x16x32_bf16 a[44:47], v[92:95], v[156:159], a[44:47]
    ds_read_b64_tr_b16 v[170:171], v6 offset:6400
    v_mfma_f32_16x16x32_bf16 a[48:51], v[96:99], v[144:147], a[48:51]
    ds_read_b64_tr_b16 v[172:173], v7 offset:6144
    v_mfma_f32_16x16x32_bf16 a[52:55], v[96:99], v[148:151], a[52:55]
    ds_read_b64_tr_b16 v[174:175], v7 offset:6400
    v_mfma_f32_16x16x32_bf16 a[48:51], v[100:103], v[152:155], a[48:51]
    v_mfma_f32_16x16x32_bf16 a[52:55], v[100:103], v[156:159], a[52:55]
    s_waitcnt vmcnt(2)
    v_mfma_f32_16x16x32_bf16 a[56:59], v[104:107], v[144:147], a[56:59]
    v_mfma_f32_16x16x32_bf16 a[60:63], v[104:107], v[148:151], a[60:63]
    v_mfma_f32_16x16x32_bf16 a[56:59], v[108:111], v[152:155], a[56:59]
    v_mfma_f32_16x16x32_bf16 a[60:63], v[108:111], v[156:159], a[60:63]
    s_waitcnt lgkmcnt(0)
    v_mfma_f32_16x16x32_bf16 a[0:3], v[120:123], v[160:163], a[0:3]
    v_mfma_f32_16x16x32_bf16 a[4:7], v[120:123], v[164:167], a[4:7]
    v_mfma_f32_16x16x32_bf16 a[0:3], v[124:127], v[168:171], a[0:3]
    v_mfma_f32_16x16x32_bf16 a[4:7], v[124:127], v[172:175], a[4:7]
    v_mov_b32_dpp v120, v120 row_shl:1 row_mask:0xf bank_mask:0xf
    v_mfma_f32_16x16x32_bf16 a[8:11], v[128:131], v[160:163], a[8:11]
    v_mov_b32_dpp v121, v121 row_shl:1 row_mask:0xf bank_mask:0xf
    v_mfma_f32_16x16x32_bf16 a[12:15], v[128:131], v[164:167], a[12:15]
    v_mov_b32_dpp v122, v122 row_shl:1 row_mask:0xf bank_mask:0xf
    v_mfma_f32_16x16x32_bf16 a[8:11], v[132:135], v[168:171], a[8:11]
    v_mov_b32_dpp v123, v123 row_shl:1 row_mask:0xf bank_mask:0xf
    v_mfma_f32_16x16x32_bf16 a[12:15], v[132:135], v[172:175], a[12:15]
    v_mov_b32_dpp v124, v124 row_shl:1 row_mask:0xf bank_mask:0xf
    v_mfma_f32_16x16x32_bf16 a[16:19], v[136:139], v[160:163], a[16:19]
    v_mov_b32_dpp v125, v125 row_shl:1 row_mask:0xf bank_mask:0xf
    v_mfma_f32_16x16x32_bf16 a[20:23], v[136:139], v[164:167], a[20:23]
    v_mov_b32_dpp v126, v126 row_shl:1 row_mask:0xf bank_mask:0xf
    v_mfma_f32_16x16x32_bf16 a[16:19], v[140:143], v[168:171], a[16:19]
    v_mov_b32_dpp v127, v127 row_shl:1 row_mask:0xf bank_mask:0xf
    v_mfma_f32_16x16x32_bf16 a[20:23], v[140:143], v[172:175], a[20:23]
    s_mov_b64 exec, s[46:47]
    buffer_load_dwordx4 v[120:123], v1, s[12:15], s35 offen offset:1536
    buffer_load_dwordx4 v[124:127], v1, s[12:15], s35 offen offset:1600
    s_mov_b64 exec, -1
    v_mfma_f32_16x16x32_bf16 a[24:27], v[80:83], v[160:163], a[24:27]
    v_mfma_f32_16x16x32_bf16 a[28:31], v[80:83], v[164:167], a[28:31]
    v_mfma_f32_16x16x32_bf16 a[24:27], v[84:87], v[168:171], a[24:27]
    v_mfma_f32_16x16x32_bf16 a[28:31], v[84:87], v[172:175], a[28:31]
    v_mfma_f32_16x16x32_bf16 a[32:35], v[88:91], v[160:163], a[32:35]
    v_mfma_f32_16x16x32_bf16 a[36:39], v[88:91], v[164:167], a[36:39]
    v_mfma_f32_16x16x32_bf16 a[32:35], v[92:95], v[168:171], a[32:35]
    ds_read_b64_tr_b16 v[144:145], v6 offset:8192
    v_mfma_f32_16x16x32_bf16 a[36:39], v[92:95], v[172:175], a[36:39]
    ds_read_b64_tr_b16 v[146:147], v6 offset:8448
    v_mfma_f32_16x16x32_bf16 a[40:43], v[96:99], v[160:163], a[40:43]
    ds_read_b64_tr_b16 v[148:149], v7 offset:8192
    v_mfma_f32_16x16x32_bf16 a[44:47], v[96:99], v[164:167], a[44:47]
    ds_read_b64_tr_b16 v[150:151], v7 offset:8448
    v_mfma_f32_16x16x32_bf16 a[40:43], v[100:103], v[168:171], a[40:43]
    ds_read_b64_tr_b16 v[152:153], v6 offset:10240
    v_mfma_f32_16x16x32_bf16 a[44:47], v[100:103], v[172:175], a[44:47]
    ds_read_b64_tr_b16 v[154:155], v6 offset:10496
    v_mfma_f32_16x16x32_bf16 a[48:51], v[104:107], v[160:163], a[48:51]
    ds_read_b64_tr_b16 v[156:157], v7 offset:10240
    v_mfma_f32_16x16x32_bf16 a[52:55], v[104:107], v[164:167], a[52:55]
    ds_read_b64_tr_b16 v[158:159], v7 offset:10496
    v_mfma_f32_16x16x32_bf16 a[48:51], v[108:111], v[168:171], a[48:51]
    v_mfma_f32_16x16x32_bf16 a[52:55], v[108:111], v[172:175], a[52:55]
    s_waitcnt vmcnt(2)
    v_mfma_f32_16x16x32_bf16 a[56:59], v[112:115], v[160:163], a[56:59]
    v_mfma_f32_16x16x32_bf16 a[60:63], v[112:115], v[164:167], a[60:63]
    v_mfma_f32_16x16x32_bf16 a[56:59], v[116:119], v[168:171], a[56:59]
    v_mfma_f32_16x16x32_bf16 a[60:63], v[116:119], v[172:175], a[60:63]
    s_waitcnt lgkmcnt(0)
    v_mfma_f32_16x16x32_bf16 a[0:3], v[128:131], v[144:147], a[0:3]
    v_mfma_f32_16x16x32_bf16 a[4:7], v[128:131], v[148:151], a[4:7]
    v_mfma_f32_16x16x32_bf16 a[0:3], v[132:135], v[152:155], a[0:3]
    v_mfma_f32_16x16x32_bf16 a[4:7], v[132:135], v[156:159], a[4:7]
    v_mfma_f32_16x16x32_bf16 a[8:11], v[136:139], v[144:147], a[8:11]
    v_mfma_f32_16x16x32_bf16 a[12:15], v[136:139], v[148:151], a[12:15]
    v_mfma_f32_16x16x32_bf16 a[8:11], v[140:143], v[152:155], a[8:11]
    v_mfma_f32_16x16x32_bf16 a[12:15], v[140:143], v[156:159], a[12:15]
    v_mfma_f32_16x16x32_bf16 a[16:19], v[80:83], v[144:147], a[16:19]
    v_mfma_f32_16x16x32_bf16 a[20:23], v[80:83], v[148:151], a[20:23]
    v_mfma_f32_16x16x32_bf16 a[16:19], v[84:87], v[152:155], a[16:19]
    v_mfma_f32_16x16x32_bf16 a[20:23], v[84:87], v[156:159], a[20:23]
    v_mfma_f32_16x16x32_bf16 a[24:27], v[88:91], v[144:147], a[24:27]
    v_mfma_f32_16x16x32_bf16 a[28:31], v[88:91], v[148:151], a[28:31]
    v_mfma_f32_16x16x32_bf16 a[24:27], v[92:95], v[152:155], a[24:27]
    v_mfma_f32_16x16x32_bf16 a[28:31], v[92:95], v[156:159], a[28:31]
    v_mfma_f32_16x16x32_bf16 a[32:35], v[96:99], v[144:147], a[32:35]
    v_mfma_f32_16x16x32_bf16 a[36:39], v[96:99], v[148:151], a[36:39]
    v_mfma_f32_16x16x32_bf16 a[32:35], v[100:103], v[152:155], a[32:35]
    v_mfma_f32_16x16x32_bf16 a[36:39], v[100:103], v[156:159], a[36:39]
    v_mfma_f32_16x16x32_bf16 a[40:43], v[104:107], v[144:147], a[40:43]
    v_mfma_f32_16x16x32_bf16 a[44:47], v[104:107], v[148:151], a[44:47]
    v_mfma_f32_16x16x32_bf16 a[40:43], v[108:111], v[152:155], a[40:43]
    v_mfma_f32_16x16x32_bf16 a[44:47], v[108:111], v[156:159], a[44:47]
    v_mfma_f32_16x16x32_bf16 a[48:51], v[112:115], v[144:147], a[48:51]
    v_mfma_f32_16x16x32_bf16 a[52:55], v[112:115], v[148:151], a[52:55]
    v_mfma_f32_16x16x32_bf16 a[48:51], v[116:119], v[152:155], a[48:51]
    v_mfma_f32_16x16x32_bf16 a[52:55], v[116:119], v[156:159], a[52:55]
    s_waitcnt vmcnt(0)
    v_mfma_f32_16x16x32_bf16 a[56:59], v[120:123], v[144:147], a[56:59]
    v_mfma_f32_16x16x32_bf16 a[60:63], v[120:123], v[148:151], a[60:63]
    v_mfma_f32_16x16x32_bf16 a[56:59], v[124:127], v[152:155], a[56:59]
    v_mfma_f32_16x16x32_bf16 a[60:63], v[124:127], v[156:159], a[60:63]
    s_waitcnt vmcnt(0)
    s_nop 7
    s_nop 7
    v_and_b32 v8, 63, v0
    v_lshlrev_b32 v9, 4, v8
    v_add_u32 v12, s28, v9
    ds_write_b128 v12, a[0:3] offset:0
    ds_write_b128 v12, a[4:7] offset:1024
    ds_write_b128 v12, a[8:11] offset:2048
    ds_write_b128 v12, a[12:15] offset:3072
    ds_write_b128 v12, a[16:19] offset:4096
    ds_write_b128 v12, a[20:23] offset:5120
    ds_write_b128 v12, a[24:27] offset:6144
    ds_write_b128 v12, a[28:31] offset:7168
    ds_write_b128 v12, a[32:35] offset:8192
    ds_write_b128 v12, a[36:39] offset:9216
    ds_write_b128 v12, a[40:43] offset:10240
    ds_write_b128 v12, a[44:47] offset:11264
    ds_write_b128 v12, a[48:51] offset:12288
    ds_write_b128 v12, a[52:55] offset:13312
    ds_write_b128 v12, a[56:59] offset:14336
    ds_write_b128 v12, a[60:63] offset:15360
    s_waitcnt lgkmcnt(0)
    s_barrier
    s_lshl_b32 s41, s3, 12
    v_add_u32 v13, s41, v9
    ds_read_b128 v[16:19], v13 offset:0
    ds_read_b128 v[20:23], v13 offset:1024
    ds_read_b128 v[24:27], v13 offset:2048
    ds_read_b128 v[28:31], v13 offset:3072
    v_add_u32 v13, 32768, v13
    ds_read_b128 v[32:35], v13 offset:0
    ds_read_b128 v[36:39], v13 offset:1024
    ds_read_b128 v[40:43], v13 offset:2048
    ds_read_b128 v[44:47], v13 offset:3072
    v_add_u32 v13, 32768, v13
    ds_read_b128 v[48:51], v13 offset:0
    ds_read_b128 v[52:55], v13 offset:1024
    ds_read_b128 v[56:59], v13 offset:2048
    ds_read_b128 v[60:63], v13 offset:3072
    v_add_u32 v13, 32768, v13
    ds_read_b128 v[64:67], v13 offset:0
    ds_read_b128 v[68:71], v13 offset:1024
    ds_read_b128 v[72:75], v13 offset:2048
    ds_read_b128 v[76:79], v13 offset:3072
    v_and_b32 v10, 15, v8
    v_lshrrev_b32 v11, 4, v8
    s_lshl_b32 s41, s29, 6
    v_lshlrev_b32 v14, 1, v10
    buffer_load_ushort v80, v14, s[24:27], s41 offen
    buffer_load_ushort v81, v14, s[24:27], s41 offen offset:32
    s_waitcnt vmcnt(0) lgkmcnt(0)
    v_lshlrev_b32 v80, 16, v80
    v_lshlrev_b32 v81, 16, v81
    v_add_f32 v16, v16, v32
    v_add_f32 v48, v48, v64
    v_add_f32 v16, v16, v48
    v_add_f32 v16, v16, v80
    v_add_f32 v17, v17, v33
    v_add_f32 v49, v49, v65
    v_add_f32 v17, v17, v49
    v_add_f32 v17, v17, v80
    v_add_f32 v18, v18, v34
    v_add_f32 v50, v50, v66
    v_add_f32 v18, v18, v50
    v_add_f32 v18, v18, v80
    v_add_f32 v19, v19, v35
    v_add_f32 v51, v51, v67
    v_add_f32 v19, v19, v51
    v_add_f32 v19, v19, v80
    v_add_f32 v20, v20, v36
    v_add_f32 v52, v52, v68
    v_add_f32 v20, v20, v52
    v_add_f32 v20, v20, v81
    v_add_f32 v21, v21, v37
    v_add_f32 v53, v53, v69
    v_add_f32 v21, v21, v53
    v_add_f32 v21, v21, v81
    v_add_f32 v22, v22, v38
    v_add_f32 v54, v54, v70
    v_add_f32 v22, v22, v54
    v_add_f32 v22, v22, v81
    v_add_f32 v23, v23, v39
    v_add_f32 v55, v55, v71
    v_add_f32 v23, v23, v55
    v_add_f32 v23, v23, v81
    v_add_f32 v24, v24, v40
    v_add_f32 v56, v56, v72
    v_add_f32 v24, v24, v56
    v_add_f32 v24, v24, v80
    v_add_f32 v25, v25, v41
    v_add_f32 v57, v57, v73
    v_add_f32 v25, v25, v57
    v_add_f32 v25, v25, v80
    v_add_f32 v26, v26, v42
    v_add_f32 v58, v58, v74
    v_add_f32 v26, v26, v58
    v_add_f32 v26, v26, v80
    v_add_f32 v27, v27, v43
    v_add_f32 v59, v59, v75
    v_add_f32 v27, v27, v59
    v_add_f32 v27, v27, v80
    v_add_f32 v28, v28, v44
    v_add_f32 v60, v60, v76
    v_add_f32 v28, v28, v60
    v_add_f32 v28, v28, v81
    v_add_f32 v29, v29, v45
    v_add_f32 v61, v61, v77
    v_add_f32 v29, v29, v61
    v_add_f32 v29, v29, v81
    v_add_f32 v30, v30, v46
    v_add_f32 v62, v62, v78
    v_add_f32 v30, v30, v62
    v_add_f32 v30, v30, v81
    v_add_f32 v31, v31, v47
    v_add_f32 v63, v63, v79
    v_add_f32 v31, v31, v63
    v_add_f32 v31, v31, v81
    v_lshlrev_b32 v14, 15, v11
    v_lshl_add_u32 v14, v10, 2, v14
    s_lshl_b32 s41, s38, 11
    s_add_u32 s41, s41, s39
    s_lshl_b32 s42, s3, 1
    s_add_u32 s41, s41, s42
    s_lshl_b32 s41, s41, 10
    s_lshl_b32 s42, s29, 7
    s_add_u32 s48, s41, s42
    s_add_u32 s41, s48, 0
    buffer_store_dword v16, v14, s[20:23], s41 offen offset:0
    s_add_u32 s41, s48, 8192
    buffer_store_dword v17, v14, s[20:23], s41 offen offset:0
    s_add_u32 s41, s48, 16384
    buffer_store_dword v18, v14, s[20:23], s41 offen offset:0
    s_add_u32 s41, s48, 24576
    buffer_store_dword v19, v14, s[20:23], s41 offen offset:0
    s_add_u32 s41, s48, 0
    buffer_store_dword v20, v14, s[20:23], s41 offen offset:64
    s_add_u32 s41, s48, 8192
    buffer_store_dword v21, v14, s[20:23], s41 offen offset:64
    s_add_u32 s41, s48, 16384
    buffer_store_dword v22, v14, s[20:23], s41 offen offset:64
    s_add_u32 s41, s48, 24576
    buffer_store_dword v23, v14, s[20:23], s41 offen offset:64
    s_add_u32 s41, s48, 1024
    buffer_store_dword v24, v14, s[20:23], s41 offen offset:0
    s_add_u32 s41, s48, 9216
    buffer_store_dword v25, v14, s[20:23], s41 offen offset:0
    s_add_u32 s41, s48, 17408
    buffer_store_dword v26, v14, s[20:23], s41 offen offset:0
    s_add_u32 s41, s48, 25600
    buffer_store_dword v27, v14, s[20:23], s41 offen offset:0
    s_add_u32 s41, s48, 1024
    buffer_store_dword v28, v14, s[20:23], s41 offen offset:64
    s_add_u32 s41, s48, 9216
    buffer_store_dword v29, v14, s[20:23], s41 offen offset:64
    s_add_u32 s41, s48, 17408
    buffer_store_dword v30, v14, s[20:23], s41 offen offset:64
    s_add_u32 s41, s48, 25600
    buffer_store_dword v31, v14, s[20:23], s41 offen offset:64
    s_lshl_b32 s42, s3, 1
    v_lshlrev_b32 v15, 5, v11
    v_add_u32 v15, s42, v15
    v_add_u32 v90, 0, v15
    v_cmp_gt_u32 vcc, s43, v90
    s_nop 1
    v_cndmask_b32 v82, 0, 1.0, vcc
    v_add_u32 v90, 8, v15
    v_cmp_gt_u32 vcc, s43, v90
    s_nop 1
    v_cndmask_b32 v83, 0, 1.0, vcc
    v_add_u32 v90, 16, v15
    v_cmp_gt_u32 vcc, s43, v90
    s_nop 1
    v_cndmask_b32 v84, 0, 1.0, vcc
    v_add_u32 v90, 24, v15
    v_cmp_gt_u32 vcc, s43, v90
    s_nop 1
    v_cndmask_b32 v85, 0, 1.0, vcc
    v_add_u32 v90, 1, v15
    v_cmp_gt_u32 vcc, s43, v90
    s_nop 1
    v_cndmask_b32 v86, 0, 1.0, vcc
    v_add_u32 v90, 9, v15
    v_cmp_gt_u32 vcc, s43, v90
    s_nop 1
    v_cndmask_b32 v87, 0, 1.0, vcc
    v_add_u32 v90, 17, v15
    v_cmp_gt_u32 vcc, s43, v90
    s_nop 1
    v_cndmask_b32 v88, 0, 1.0, vcc
    v_add_u32 v90, 25, v15
    v_cmp_gt_u32 vcc, s43, v90
    s_nop 1
    v_cndmask_b32 v89, 0, 1.0, vcc
    v_mov_b32 v91, 0
    v_mov_b32 v92, 0
    v_mov_b32 v93, 0
    v_add_f32 v91, v91, v82
    v_fmac_f32 v92, v16, v82
    v_fmac_f32 v93, v20, v82
    v_add_f32 v91, v91, v83
    v_fmac_f32 v92, v17, v83
    v_fmac_f32 v93, v21, v83
    v_add_f32 v91, v91, v84
    v_fmac_f32 v92, v18, v84
    v_fmac_f32 v93, v22, v84
    v_add_f32 v91, v91, v85
    v_fmac_f32 v92, v19, v85
    v_fmac_f32 v93, v23, v85
    v_add_f32 v91, v91, v86
    v_fmac_f32 v92, v24, v86
    v_fmac_f32 v93, v28, v86
    v_add_f32 v91, v91, v87
    v_fmac_f32 v92, v25, v87
    v_fmac_f32 v93, v29, v87
    v_add_f32 v91, v91, v88
    v_fmac_f32 v92, v26, v88
    v_fmac_f32 v93, v30, v88
    v_add_f32 v91, v91, v89
    v_fmac_f32 v92, v27, v89
    v_fmac_f32 v93, v31, v89
    v_mov_b32 v120, v91
    v_mov_b32 v121, v92
    v_mov_b32 v122, v93
    s_nop 1
    v_permlane32_swap_b32 v91, v120
    v_permlane32_swap_b32 v92, v121
    v_permlane32_swap_b32 v93, v122
    s_nop 1
    v_add_f32 v91, v91, v120
    v_add_f32 v92, v92, v121
    v_add_f32 v93, v93, v122
    v_mov_b32 v120, v91
    v_mov_b32 v121, v92
    v_mov_b32 v122, v93
    s_nop 1
    v_permlane16_swap_b32 v91, v120
    v_permlane16_swap_b32 v92, v121
    v_permlane16_swap_b32 v93, v122
    s_nop 1
    v_add_f32 v91, v91, v120
    v_add_f32 v92, v92, v121
    v_add_f32 v93, v93, v122
    v_rcp_f32 v94, v91
    s_nop 0
    v_mul_f32 v92, v92, v94
    v_mul_f32 v93, v93, v94
    v_mov_b32 v95, 0
    v_mov_b32 v96, 0
    v_sub_f32 v97, v16, v92
    v_mul_f32 v97, v97, v82
    v_fmac_f32 v95, v97, v97
    v_sub_f32 v97, v20, v93
    v_mul_f32 v97, v97, v82
    v_fmac_f32 v96, v97, v97
    v_sub_f32 v97, v17, v92
    v_mul_f32 v97, v97, v83
    v_fmac_f32 v95, v97, v97
    v_sub_f32 v97, v21, v93
    v_mul_f32 v97, v97, v83
    v_fmac_f32 v96, v97, v97
    v_sub_f32 v97, v18, v92
    v_mul_f32 v97, v97, v84
    v_fmac_f32 v95, v97, v97
    v_sub_f32 v97, v22, v93
    v_mul_f32 v97, v97, v84
    v_fmac_f32 v96, v97, v97
    v_sub_f32 v97, v19, v92
    v_mul_f32 v97, v97, v85
    v_fmac_f32 v95, v97, v97
    v_sub_f32 v97, v23, v93
    v_mul_f32 v97, v97, v85
    v_fmac_f32 v96, v97, v97
    v_sub_f32 v97, v24, v92
    v_mul_f32 v97, v97, v86
    v_fmac_f32 v95, v97, v97
    v_sub_f32 v97, v28, v93
    v_mul_f32 v97, v97, v86
    v_fmac_f32 v96, v97, v97
    v_sub_f32 v97, v25, v92
    v_mul_f32 v97, v97, v87
    v_fmac_f32 v95, v97, v97
    v_sub_f32 v97, v29, v93
    v_mul_f32 v97, v97, v87
    v_fmac_f32 v96, v97, v97
    v_sub_f32 v97, v26, v92
    v_mul_f32 v97, v97, v88
    v_fmac_f32 v95, v97, v97
    v_sub_f32 v97, v30, v93
    v_mul_f32 v97, v97, v88
    v_fmac_f32 v96, v97, v97
    v_sub_f32 v97, v27, v92
    v_mul_f32 v97, v97, v89
    v_fmac_f32 v95, v97, v97
    v_sub_f32 v97, v31, v93
    v_mul_f32 v97, v97, v89
    v_fmac_f32 v96, v97, v97
    v_mov_b32 v120, v95
    v_mov_b32 v121, v96
    s_nop 1
    v_permlane32_swap_b32 v95, v120
    v_permlane32_swap_b32 v96, v121
    s_nop 1
    v_add_f32 v95, v95, v120
    v_add_f32 v96, v96, v121
    v_mov_b32 v120, v95
    v_mov_b32 v121, v96
    s_nop 1
    v_permlane16_swap_b32 v95, v120
    v_permlane16_swap_b32 v96, v121
    s_nop 1
    v_add_f32 v95, v95, v120
    v_add_f32 v96, v96, v121
    s_lshl_b32 s41, s3, 9
    v_lshlrev_b32 v14, 4, v10
    v_add_u32 v14, s41, v14
    v_add_u32 v14, 131072, v14
    s_mov_b64 exec, 0xffff
    v_mov_b32 v100, v92
    v_mov_b32 v101, v95
    v_mov_b32 v102, v91
    v_mov_b32 v103, 0
    ds_write_b128 v14, v[100:103] offset:0
    v_mov_b32 v100, v93
    v_mov_b32 v101, v96
    v_mov_b32 v102, v91
    v_mov_b32 v103, 0
    ds_write_b128 v14, v[100:103] offset:256
    s_mov_b64 exec, -1
    s_waitcnt lgkmcnt(0)
    s_barrier
    s_cmp_lg_u32 s3, 0
    s_cbranch_scc1 KA_END
    s_mov_b32 exec_lo, -1
    s_mov_b32 exec_hi, 0
    v_lshlrev_b32 v14, 4, v8
    v_add_u32 v14, 131072, v14
    ds_read_b128 v[100:103], v14 offset:0
    ds_read_b128 v[104:107], v14 offset:512
    ds_read_b128 v[108:111], v14 offset:1024
    ds_read_b128 v[112:115], v14 offset:1536
    s_waitcnt lgkmcnt(0)
    v_add_f32 v90, v102, v106
    v_add_f32 v91, v110, v114
    v_add_f32 v90, v90, v91
    v_mul_f32 v91, v100, v102
    v_fmac_f32 v91, v104, v106
    v_fmac_f32 v91, v108, v110
    v_fmac_f32 v91, v112, v114
    v_rcp_f32 v92, v90
    s_nop 0
    v_mul_f32 v91, v91, v92
    v_add_f32 v93, v101, v105
    v_add_f32 v94, v109, v113
    v_add_f32 v93, v93, v94
    v_sub_f32 v94, v100, v91
    v_mul_f32 v95, v94, v102
    v_fmac_f32 v93, v94, v95
    v_sub_f32 v94, v104, v91
    v_mul_f32 v95, v94, v106
    v_fmac_f32 v93, v94, v95
    v_sub_f32 v94, v108, v91
    v_mul_f32 v95, v94, v110
    v_fmac_f32 v93, v94, v95
    v_sub_f32 v94, v112, v91
    v_mul_f32 v95, v94, v114
    v_fmac_f32 v93, v94, v95
    s_lshl_b32 s41, s38, 4
    s_add_u32 s41, s41, s40
    s_lshl_b32 s41, s41, 10
    s_lshl_b32 s42, s29, 7
    s_add_u32 s41, s41, s42
    s_add_u32 s41, s41, 4194304
    v_lshlrev_b32 v14, 2, v8
    buffer_store_dword v91, v14, s[20:23], s41 offen
    s_add_u32 s41, s41, 32768
    buffer_store_dword v93, v14, s[20:23], s41 offen
KA_END:
KA_EXIT:
    s_endpgm
.globl hubert_norm_kernel
.p2align 8
.type hubert_norm_kernel,@function
hubert_norm_kernel:
    s_cmp_ge_u32 s2, 250
    s_cbranch_scc1 KB_EXIT
    s_load_dwordx4 s[4:7], s[0:1], 24
    s_load_dwordx2 s[8:9], s[0:1], 40
    s_load_dwordx2 s[10:11], s[0:1], 56
    v_and_b32 v1, 127, v0
    v_lshrrev_b32 v2, 7, v0
    s_nop 0
    v_readfirstlane_b32 s3, v2
    s_cmp_ge_u32 s2, 125
    s_cselect_b32 s30, 1, 0
    s_mul_i32 s31, s30, 125
    s_sub_u32 s31, s2, s31
    s_lshl_b32 s31, s31, 4
    s_add_u32 s32, s31, s3
    s_waitcnt lgkmcnt(0)
    s_mov_b32 s12, s4
    s_and_b32 s13, s5, 0xffff
    s_mov_b32 s14, 512
    s_mov_b32 s15, 0x00020000
    s_mov_b32 s16, s6
    s_and_b32 s17, s7, 0xffff
    s_mov_b32 s18, 512
    s_mov_b32 s19, 0x00020000
    s_mov_b32 s20, s8
    s_and_b32 s21, s9, 0xffff
    s_mov_b32 s22, 2032640
    s_mov_b32 s23, 0x00020000
    s_mov_b32 s24, s10
    s_and_b32 s25, s11, 0xffff
    s_mov_b32 s26, 4259840
    s_mov_b32 s27, 0x00020000
    v_lshlrev_b32 v3, 3, v1
    v_lshlrev_b32 v4, 2, v1
    s_lshl_b32 s33, s30, 11
    s_add_u32 s33, s33, s32
    s_lshl_b32 s33, s33, 10
    buffer_load_dwordx2 v[16:17], v3, s[24:27], s33 offen
    s_add_u32 s34, s33, 2048
    buffer_load_dwordx2 v[18:19], v3, s[24:27], s34 offen
    s_add_u32 s34, s33, 4096
    buffer_load_dwordx2 v[20:21], v3, s[24:27], s34 offen
    s_add_u32 s34, s33, 6144
    buffer_load_dwordx2 v[22:23], v3, s[24:27], s34 offen
    s_add_u32 s34, s33, 8192
    buffer_load_dwordx2 v[24:25], v3, s[24:27], s34 offen
    s_add_u32 s34, s33, 10240
    buffer_load_dwordx2 v[26:27], v3, s[24:27], s34 offen
    s_add_u32 s34, s33, 12288
    buffer_load_dwordx2 v[28:29], v3, s[24:27], s34 offen
    s_add_u32 s34, s33, 14336
    buffer_load_dwordx2 v[30:31], v3, s[24:27], s34 offen
    s_lshl_b32 s35, s30, 14
    s_add_u32 s35, s35, 4194304
    s_add_u32 s36, s35, 0
    buffer_load_dwordx2 v[32:33], v3, s[24:27], s36 offen offset:0
    buffer_load_dwordx2 v[34:35], v3, s[24:27], s36 offen offset:1024
    buffer_load_dwordx2 v[36:37], v3, s[24:27], s36 offen offset:2048
    buffer_load_dwordx2 v[38:39], v3, s[24:27], s36 offen offset:3072
    s_add_u32 s36, s35, 4096
    buffer_load_dwordx2 v[40:41], v3, s[24:27], s36 offen offset:0
    buffer_load_dwordx2 v[42:43], v3, s[24:27], s36 offen offset:1024
    buffer_load_dwordx2 v[44:45], v3, s[24:27], s36 offen offset:2048
    buffer_load_dwordx2 v[46:47], v3, s[24:27], s36 offen offset:3072
    s_add_u32 s36, s35, 8192
    buffer_load_dwordx2 v[48:49], v3, s[24:27], s36 offen offset:0
    buffer_load_dwordx2 v[50:51], v3, s[24:27], s36 offen offset:1024
    buffer_load_dwordx2 v[52:53], v3, s[24:27], s36 offen offset:2048
    buffer_load_dwordx2 v[54:55], v3, s[24:27], s36 offen offset:3072
    s_add_u32 s36, s35, 12288
    buffer_load_dwordx2 v[56:57], v3, s[24:27], s36 offen offset:0
    buffer_load_dwordx2 v[58:59], v3, s[24:27], s36 offen offset:1024
    buffer_load_dwordx2 v[60:61], v3, s[24:27], s36 offen offset:2048
    buffer_load_dwordx2 v[62:63], v3, s[24:27], s36 offen offset:3072
    s_add_u32 s36, s35, 32768
    buffer_load_dwordx2 v[64:65], v3, s[24:27], s36 offen offset:0
    buffer_load_dwordx2 v[66:67], v3, s[24:27], s36 offen offset:1024
    buffer_load_dwordx2 v[68:69], v3, s[24:27], s36 offen offset:2048
    buffer_load_dwordx2 v[70:71], v3, s[24:27], s36 offen offset:3072
    s_add_u32 s36, s35, 36864
    buffer_load_dwordx2 v[72:73], v3, s[24:27], s36 offen offset:0
    buffer_load_dwordx2 v[74:75], v3, s[24:27], s36 offen offset:1024
    buffer_load_dwordx2 v[76:77], v3, s[24:27], s36 offen offset:2048
    buffer_load_dwordx2 v[78:79], v3, s[24:27], s36 offen offset:3072
    s_add_u32 s36, s35, 40960
    buffer_load_dwordx2 v[80:81], v3, s[24:27], s36 offen offset:0
    buffer_load_dwordx2 v[82:83], v3, s[24:27], s36 offen offset:1024
    buffer_load_dwordx2 v[84:85], v3, s[24:27], s36 offen offset:2048
    buffer_load_dwordx2 v[86:87], v3, s[24:27], s36 offen offset:3072
    s_add_u32 s36, s35, 45056
    buffer_load_dwordx2 v[88:89], v3, s[24:27], s36 offen offset:0
    buffer_load_dwordx2 v[90:91], v3, s[24:27], s36 offen offset:1024
    buffer_load_dwordx2 v[92:93], v3, s[24:27], s36 offen offset:2048
    buffer_load_dwordx2 v[94:95], v3, s[24:27], s36 offen offset:3072
    buffer_load_dword v96, v4, s[12:15], 0 offen
    buffer_load_dword v97, v4, s[16:19], 0 offen
    s_waitcnt vmcnt(0)
    v_mov_b32 v110, 0x3a040ffe
    v_mov_b32 v111, 0x43000000
    v_mov_b32 v112, 0x42820000
    v_mov_b32 v113, 0x3727c5ac
    v_mov_b32 v114, 0xc0135761
    v_mov_b32 v115, 0xbdd2d3e8
    v_add_f32 v98, v32, v34
    v_add_f32 v98, v98, v36
    v_add_f32 v98, v98, v38
    v_add_f32 v98, v98, v40
    v_add_f32 v98, v98, v42
    v_add_f32 v98, v98, v44
    v_add_f32 v98, v98, v46
    v_add_f32 v98, v98, v48
    v_add_f32 v98, v98, v50
    v_add_f32 v98, v98, v52
    v_add_f32 v98, v98, v54
    v_add_f32 v98, v98, v56
    v_add_f32 v98, v98, v58
    v_add_f32 v98, v98, v60
    v_mul_f32 v98, v98, v111
    v_fmac_f32 v98, v62, v112
    v_mul_f32 v98, v98, v110
    v_add_f32 v99, v64, v66
    v_add_f32 v99, v99, v68
    v_add_f32 v99, v99, v70
    v_add_f32 v99, v99, v72
    v_add_f32 v99, v99, v74
    v_add_f32 v99, v99, v76
    v_add_f32 v99, v99, v78
    v_add_f32 v99, v99, v80
    v_add_f32 v99, v99, v82
    v_add_f32 v99, v99, v84
    v_add_f32 v99, v99, v86
    v_add_f32 v99, v99, v88
    v_add_f32 v99, v99, v90
    v_add_f32 v99, v99, v92
    v_add_f32 v99, v99, v94
    v_mov_b32 v100, 0
    v_sub_f32 v101, v32, v98
    v_fmac_f32 v100, v101, v101
    v_sub_f32 v101, v34, v98
    v_fmac_f32 v100, v101, v101
    v_sub_f32 v101, v36, v98
    v_fmac_f32 v100, v101, v101
    v_sub_f32 v101, v38, v98
    v_fmac_f32 v100, v101, v101
    v_sub_f32 v101, v40, v98
    v_fmac_f32 v100, v101, v101
    v_sub_f32 v101, v42, v98
    v_fmac_f32 v100, v101, v101
    v_sub_f32 v101, v44, v98
    v_fmac_f32 v100, v101, v101
    v_sub_f32 v101, v46, v98
    v_fmac_f32 v100, v101, v101
    v_sub_f32 v101, v48, v98
    v_fmac_f32 v100, v101, v101
    v_sub_f32 v101, v50, v98
    v_fmac_f32 v100, v101, v101
    v_sub_f32 v101, v52, v98
    v_fmac_f32 v100, v101, v101
    v_sub_f32 v101, v54, v98
    v_fmac_f32 v100, v101, v101
    v_sub_f32 v101, v56, v98
    v_fmac_f32 v100, v101, v101
    v_sub_f32 v101, v58, v98
    v_fmac_f32 v100, v101, v101
    v_sub_f32 v101, v60, v98
    v_fmac_f32 v100, v101, v101
    v_fmac_f32 v99, v100, v111
    v_sub_f32 v101, v62, v98
    v_mul_f32 v101, v101, v101
    v_fmac_f32 v99, v101, v112
    v_mul_f32 v99, v99, v110
    v_add_f32 v99, v99, v113
    v_rsq_f32 v99, v99
    s_nop 0
    v_lshlrev_b32 v100, 16, v96
    v_lshlrev_b32 v101, 16, v97
    v_mul_f32 v104, v99, v100
    v_fma_f32 v106, -v98, v104, v101
    v_add_f32 v98, v33, v35
    v_add_f32 v98, v98, v37
    v_add_f32 v98, v98, v39
    v_add_f32 v98, v98, v41
    v_add_f32 v98, v98, v43
    v_add_f32 v98, v98, v45
    v_add_f32 v98, v98, v47
    v_add_f32 v98, v98, v49
    v_add_f32 v98, v98, v51
    v_add_f32 v98, v98, v53
    v_add_f32 v98, v98, v55
    v_add_f32 v98, v98, v57
    v_add_f32 v98, v98, v59
    v_add_f32 v98, v98, v61
    v_mul_f32 v98, v98, v111
    v_fmac_f32 v98, v63, v112
    v_mul_f32 v98, v98, v110
    v_add_f32 v99, v65, v67
    v_add_f32 v99, v99, v69
    v_add_f32 v99, v99, v71
    v_add_f32 v99, v99, v73
    v_add_f32 v99, v99, v75
    v_add_f32 v99, v99, v77
    v_add_f32 v99, v99, v79
    v_add_f32 v99, v99, v81
    v_add_f32 v99, v99, v83
    v_add_f32 v99, v99, v85
    v_add_f32 v99, v99, v87
    v_add_f32 v99, v99, v89
    v_add_f32 v99, v99, v91
    v_add_f32 v99, v99, v93
    v_add_f32 v99, v99, v95
    v_mov_b32 v100, 0
    v_sub_f32 v101, v33, v98
    v_fmac_f32 v100, v101, v101
    v_sub_f32 v101, v35, v98
    v_fmac_f32 v100, v101, v101
    v_sub_f32 v101, v37, v98
    v_fmac_f32 v100, v101, v101
    v_sub_f32 v101, v39, v98
    v_fmac_f32 v100, v101, v101
    v_sub_f32 v101, v41, v98
    v_fmac_f32 v100, v101, v101
    v_sub_f32 v101, v43, v98
    v_fmac_f32 v100, v101, v101
    v_sub_f32 v101, v45, v98
    v_fmac_f32 v100, v101, v101
    v_sub_f32 v101, v47, v98
    v_fmac_f32 v100, v101, v101
    v_sub_f32 v101, v49, v98
    v_fmac_f32 v100, v101, v101
    v_sub_f32 v101, v51, v98
    v_fmac_f32 v100, v101, v101
    v_sub_f32 v101, v53, v98
    v_fmac_f32 v100, v101, v101
    v_sub_f32 v101, v55, v98
    v_fmac_f32 v100, v101, v101
    v_sub_f32 v101, v57, v98
    v_fmac_f32 v100, v101, v101
    v_sub_f32 v101, v59, v98
    v_fmac_f32 v100, v101, v101
    v_sub_f32 v101, v61, v98
    v_fmac_f32 v100, v101, v101
    v_fmac_f32 v99, v100, v111
    v_sub_f32 v101, v63, v98
    v_mul_f32 v101, v101, v101
    v_fmac_f32 v99, v101, v112
    v_mul_f32 v99, v99, v110
    v_add_f32 v99, v99, v113
    v_rsq_f32 v99, v99
    s_nop 0
    v_and_b32 v100, 0xffff0000, v96
    v_and_b32 v101, 0xffff0000, v97
    v_mul_f32 v105, v99, v100
    v_fma_f32 v107, -v98, v105, v101
    s_mul_i32 s37, s30, 1985
    s_add_u32 s37, s37, s32
    s_lshl_b32 s37, s37, 9
    s_add_u32 s38, s32, 0
    s_cmp_ge_u32 s38, 1985
    s_cbranch_scc1 KB_END
    v_fma_f32 v116, v16, v104, v106
    v_mul_f32 v117, v116, v116
    v_fma_f32 v117, v117, v115, v114
    v_mul_f32 v117, v117, v116
    v_exp_f32 v117, v117
    s_nop 0
    v_add_f32 v117, 1.0, v117
    v_rcp_f32 v117, v117
    s_nop 0
    v_mul_f32 v118, v116, v117
    v_fma_f32 v116, v17, v105, v107
    v_mul_f32 v117, v116, v116
    v_fma_f32 v117, v117, v115, v114
    v_mul_f32 v117, v117, v116
    v_exp_f32 v117, v117
    s_nop 0
    v_add_f32 v117, 1.0, v117
    v_rcp_f32 v117, v117
    s_nop 0
    v_mul_f32 v119, v116, v117
    v_cvt_pk_bf16_f32 v120, v118, v119
    s_add_u32 s39, s37, 0
    buffer_store_dword v120, v4, s[20:23], s39 offen
    s_add_u32 s38, s32, 2
    s_cmp_ge_u32 s38, 1985
    s_cbranch_scc1 KB_END
    v_fma_f32 v116, v18, v104, v106
    v_mul_f32 v117, v116, v116
    v_fma_f32 v117, v117, v115, v114
    v_mul_f32 v117, v117, v116
    v_exp_f32 v117, v117
    s_nop 0
    v_add_f32 v117, 1.0, v117
    v_rcp_f32 v117, v117
    s_nop 0
    v_mul_f32 v118, v116, v117
    v_fma_f32 v116, v19, v105, v107
    v_mul_f32 v117, v116, v116
    v_fma_f32 v117, v117, v115, v114
    v_mul_f32 v117, v117, v116
    v_exp_f32 v117, v117
    s_nop 0
    v_add_f32 v117, 1.0, v117
    v_rcp_f32 v117, v117
    s_nop 0
    v_mul_f32 v119, v116, v117
    v_cvt_pk_bf16_f32 v120, v118, v119
    s_add_u32 s39, s37, 1024
    buffer_store_dword v120, v4, s[20:23], s39 offen
    s_add_u32 s38, s32, 4
    s_cmp_ge_u32 s38, 1985
    s_cbranch_scc1 KB_END
    v_fma_f32 v116, v20, v104, v106
    v_mul_f32 v117, v116, v116
    v_fma_f32 v117, v117, v115, v114
    v_mul_f32 v117, v117, v116
    v_exp_f32 v117, v117
    s_nop 0
    v_add_f32 v117, 1.0, v117
    v_rcp_f32 v117, v117
    s_nop 0
    v_mul_f32 v118, v116, v117
    v_fma_f32 v116, v21, v105, v107
    v_mul_f32 v117, v116, v116
    v_fma_f32 v117, v117, v115, v114
    v_mul_f32 v117, v117, v116
    v_exp_f32 v117, v117
    s_nop 0
    v_add_f32 v117, 1.0, v117
    v_rcp_f32 v117, v117
    s_nop 0
    v_mul_f32 v119, v116, v117
    v_cvt_pk_bf16_f32 v120, v118, v119
    s_add_u32 s39, s37, 2048
    buffer_store_dword v120, v4, s[20:23], s39 offen
    s_add_u32 s38, s32, 6
    s_cmp_ge_u32 s38, 1985
    s_cbranch_scc1 KB_END
    v_fma_f32 v116, v22, v104, v106
    v_mul_f32 v117, v116, v116
    v_fma_f32 v117, v117, v115, v114
    v_mul_f32 v117, v117, v116
    v_exp_f32 v117, v117
    s_nop 0
    v_add_f32 v117, 1.0, v117
    v_rcp_f32 v117, v117
    s_nop 0
    v_mul_f32 v118, v116, v117
    v_fma_f32 v116, v23, v105, v107
    v_mul_f32 v117, v116, v116
    v_fma_f32 v117, v117, v115, v114
    v_mul_f32 v117, v117, v116
    v_exp_f32 v117, v117
    s_nop 0
    v_add_f32 v117, 1.0, v117
    v_rcp_f32 v117, v117
    s_nop 0
    v_mul_f32 v119, v116, v117
    v_cvt_pk_bf16_f32 v120, v118, v119
    s_add_u32 s39, s37, 3072
    buffer_store_dword v120, v4, s[20:23], s39 offen
    s_add_u32 s38, s32, 8
    s_cmp_ge_u32 s38, 1985
    s_cbranch_scc1 KB_END
    v_fma_f32 v116, v24, v104, v106
    v_mul_f32 v117, v116, v116
    v_fma_f32 v117, v117, v115, v114
    v_mul_f32 v117, v117, v116
    v_exp_f32 v117, v117
    s_nop 0
    v_add_f32 v117, 1.0, v117
    v_rcp_f32 v117, v117
    s_nop 0
    v_mul_f32 v118, v116, v117
    v_fma_f32 v116, v25, v105, v107
    v_mul_f32 v117, v116, v116
    v_fma_f32 v117, v117, v115, v114
    v_mul_f32 v117, v117, v116
    v_exp_f32 v117, v117
    s_nop 0
    v_add_f32 v117, 1.0, v117
    v_rcp_f32 v117, v117
    s_nop 0
    v_mul_f32 v119, v116, v117
    v_cvt_pk_bf16_f32 v120, v118, v119
    s_add_u32 s39, s37, 4096
    buffer_store_dword v120, v4, s[20:23], s39 offen
    s_add_u32 s38, s32, 10
    s_cmp_ge_u32 s38, 1985
    s_cbranch_scc1 KB_END
    v_fma_f32 v116, v26, v104, v106
    v_mul_f32 v117, v116, v116
    v_fma_f32 v117, v117, v115, v114
    v_mul_f32 v117, v117, v116
    v_exp_f32 v117, v117
    s_nop 0
    v_add_f32 v117, 1.0, v117
    v_rcp_f32 v117, v117
    s_nop 0
    v_mul_f32 v118, v116, v117
    v_fma_f32 v116, v27, v105, v107
    v_mul_f32 v117, v116, v116
    v_fma_f32 v117, v117, v115, v114
    v_mul_f32 v117, v117, v116
    v_exp_f32 v117, v117
    s_nop 0
    v_add_f32 v117, 1.0, v117
    v_rcp_f32 v117, v117
    s_nop 0
    v_mul_f32 v119, v116, v117
    v_cvt_pk_bf16_f32 v120, v118, v119
    s_add_u32 s39, s37, 5120
    buffer_store_dword v120, v4, s[20:23], s39 offen
    s_add_u32 s38, s32, 12
    s_cmp_ge_u32 s38, 1985
    s_cbranch_scc1 KB_END
    v_fma_f32 v116, v28, v104, v106
    v_mul_f32 v117, v116, v116
    v_fma_f32 v117, v117, v115, v114
    v_mul_f32 v117, v117, v116
    v_exp_f32 v117, v117
    s_nop 0
    v_add_f32 v117, 1.0, v117
    v_rcp_f32 v117, v117
    s_nop 0
    v_mul_f32 v118, v116, v117
    v_fma_f32 v116, v29, v105, v107
    v_mul_f32 v117, v116, v116
    v_fma_f32 v117, v117, v115, v114
    v_mul_f32 v117, v117, v116
    v_exp_f32 v117, v117
    s_nop 0
    v_add_f32 v117, 1.0, v117
    v_rcp_f32 v117, v117
    s_nop 0
    v_mul_f32 v119, v116, v117
    v_cvt_pk_bf16_f32 v120, v118, v119
    s_add_u32 s39, s37, 6144
    buffer_store_dword v120, v4, s[20:23], s39 offen
    s_add_u32 s38, s32, 14
    s_cmp_ge_u32 s38, 1985
    s_cbranch_scc1 KB_END
    v_fma_f32 v116, v30, v104, v106
    v_mul_f32 v117, v116, v116
    v_fma_f32 v117, v117, v115, v114
    v_mul_f32 v117, v117, v116
    v_exp_f32 v117, v117
    s_nop 0
    v_add_f32 v117, 1.0, v117
    v_rcp_f32 v117, v117
    s_nop 0
    v_mul_f32 v118, v116, v117
    v_fma_f32 v116, v31, v105, v107
    v_mul_f32 v117, v116, v116
    v_fma_f32 v117, v117, v115, v114
    v_mul_f32 v117, v117, v116
    v_exp_f32 v117, v117
    s_nop 0
    v_add_f32 v117, 1.0, v117
    v_rcp_f32 v117, v117
    s_nop 0
    v_mul_f32 v119, v116, v117
    v_cvt_pk_bf16_f32 v120, v118, v119
    s_add_u32 s39, s37, 7168
    buffer_store_dword v120, v4, s[20:23], s39 offen
KB_END:
KB_EXIT:
    s_endpgm
.section .rodata,"a"
.p2align 6
.amdhsa_kernel standalone__self_sup_conv_stem_hubert__speech_kernel
  .amdhsa_next_free_vgpr 240
  .amdhsa_next_free_sgpr 64
  .amdhsa_accum_offset 176
  .amdhsa_group_segment_fixed_size 0
  .amdhsa_kernarg_size 64
  .amdhsa_user_sgpr_count 2
  .amdhsa_user_sgpr_kernarg_segment_ptr 1
  .amdhsa_system_sgpr_workgroup_id_x 1
.end_amdhsa_kernel
.p2align 6
.amdhsa_kernel hubert_norm_kernel
  .amdhsa_next_free_vgpr 128
  .amdhsa_next_free_sgpr 64
  .amdhsa_accum_offset 128
  .amdhsa_group_segment_fixed_size 0
  .amdhsa_kernarg_size 64
  .amdhsa_user_sgpr_count 2
  .amdhsa_user_sgpr_kernarg_segment_ptr 1
  .amdhsa_system_sgpr_workgroup_id_x 1
.end_amdhsa_kernel
```
